```python
import torch

def _softmax(x, axis=-1):
    return torch.softmax(x, dim=axis)
def _gelu(x):
    return torch.nn.functional.gelu(x, approximate="tanh")
def _silu(x):
    return torch.nn.functional.silu(x)
def _sigmoid(x):
    return torch.sigmoid(x)
def _layernorm(x, axis=-1, eps=1e-5):
    m = x.mean(dim=axis, keepdim=True)
    v = x.var(dim=axis, keepdim=True, unbiased=False)
    return (x - m) / torch.sqrt(v + eps)
def _scatter_add(tgt, idx, src, axis=0):
    return tgt.clone().index_add_(axis, idx, src)
def _segment_sum(src, seg, n):
    out = torch.zeros((n,) + src.shape[1:], dtype=src.dtype)
    return out.index_add_(0, seg, src)
def _pad(x, pw):
    flat = tuple(v for pair in reversed(pw) for v in pair)
    return torch.nn.functional.pad(x, flat)

kernel_name = 'sequential_preLN__grouped_kv_mqa__dense_activation_mish__prompt'

def setup_inputs():

    _w = (lambda a: (lambda t: t.to(torch.bfloat16) if t.is_floating_point() else t)(torch.as_tensor(a)))
    def _A_setup():
        B, S, D, H = 1, 2048, 512, 32
        Dh = D // H
        return {
            "x": _w((lambda *s: torch.randn(*s, dtype=torch.bfloat16) * 0.05)(B, S, D)),
            "wq": _w((lambda *s: torch.randn(*s, dtype=torch.bfloat16) * 0.05)(D, H * Dh)),
            "wk": _w((lambda *s: torch.randn(*s, dtype=torch.bfloat16) * 0.05)(D, Dh)),
            "wv": _w((lambda *s: torch.randn(*s, dtype=torch.bfloat16) * 0.05)(D, Dh)),
            "wo": _w((lambda *s: torch.randn(*s, dtype=torch.bfloat16) * 0.05)(H * Dh, D)),
        }
    _A_in = _A_setup()

    def _B_setup():
        B, S, D, F = 1, 2048, 512, 1792
        return {
            "x": _w((lambda *s: torch.randn(*s, dtype=torch.bfloat16) * 0.05)(B, S, D)),
            "w1": _w((lambda *s: torch.randn(*s, dtype=torch.bfloat16) * 0.8)(D, F) * (D ** -0.5)),
            "b1": _w((lambda *s: torch.randn(*s, dtype=torch.bfloat16) * 0.4)(F)),
            "w2": _w((lambda *s: torch.randn(*s, dtype=torch.bfloat16) * 0.2)(F, D) * (F ** -0.5)),
        }
    _B_in = _B_setup()

    return {
        "A_x": _A_in["x"],
        "A_wq": _A_in["wq"],
        "A_wk": _A_in["wk"],
        "A_wv": _A_in["wv"],
        "A_wo": _A_in["wo"],
        "B_x": _B_in["x"],
        "B_w1": _B_in["w1"],
        "B_b1": _B_in["b1"],
        "B_w2": _B_in["w2"],
    }

def reference(A_x, A_wq, A_wk, A_wv, A_wo, B_x, B_w1, B_b1, B_w2):
    def _A_ref(x, wq, wk, wv, wo):
        B, S, D = x.shape
        H = 32
        Dh = D // H
        q = (lambda x, *d: x.permute(*d))((x @ wq).reshape(B, S, H, Dh), 0, 2, 1, 3)
        k = x @ wk
        v = x @ wv
        scores = torch.einsum("bhqd,bkd->bhqk", q, k) * (Dh ** -0.5)
        p = _softmax(scores, axis=-1)
        o = torch.einsum("bhqk,bkd->bhqd", p, v)
        return (lambda x, *d: x.permute(*d))(o, 0, 2, 1, 3).reshape(B, S, H * Dh) @ wo

    def _B_ref(x, w1, b1, w2):
        h = torch.einsum("bsd,df->bsf", x, w1) + b1
        sp = torch.log1p(torch.exp(-torch.abs(h))) + torch.where(h > 0, h, torch.zeros_like(h))
        act = h * torch.tanh(sp)
        return torch.einsum("bsf,fd->bsd", act, w2)

    x = A_x
    h = x + _A_ref(_layernorm(x, axis=-1), A_wq, A_wk, A_wv, A_wo)
    h2 = h + _B_ref(_layernorm(h, axis=-1), B_w1, B_b1, B_w2)
    return h2
```

```asm
; @launch grid=(256,1,1) block=(512,1,1) lds=163840
.amdgcn_target "amdgcn-amd-amdhsa--gfx950"
.text
.globl sequential_preLN__grouped_kv_mqa__dense_activation_mish__prompt_kernel
.p2align 8
.type sequential_preLN__grouped_kv_mqa__dense_activation_mish__prompt_kernel,@function
sequential_preLN__grouped_kv_mqa__dense_activation_mish__prompt_kernel:
    s_cmp_ge_u32 s2, 256
    s_cbranch_scc1 K_END
    s_load_dwordx4 s[4:7], s[0:1], 0
    s_load_dwordx4 s[8:11], s[0:1], 16
    s_load_dwordx2 s[12:13], s[0:1], 32
    s_load_dwordx2 s[14:15], s[0:1], 48
    s_load_dwordx4 s[64:67], s[0:1], 56
    s_load_dwordx4 s[16:19], s[0:1], 72
    s_load_dwordx2 s[62:63], s[0:1], 88
    v_lshrrev_b32 v2, 6, v0
    v_and_b32 v1, 63, v0
    v_readfirstlane_b32 s3, v2
    s_and_b32 s40, s2, 7
    s_lshr_b32 s42, s2, 6
    s_lshl_b32 s42, s42, 3
    s_or_b32 s40, s40, s42
    s_lshr_b32 s41, s2, 3
    s_and_b32 s41, s41, 7
    s_and_b32 s42, s3, 1
    s_lshl_b32 s43, s42, 3
    v_xor_b32 v10, s43, v1
    v_lshlrev_b32 v10, 4, v10
    v_xor_b32 v11, 16, v10
    v_xor_b32 v12, 32, v10
    v_xor_b32 v13, 48, v10
    v_xor_b32 v14, 64, v10
    v_xor_b32 v15, 80, v10
    v_xor_b32 v16, 96, v10
    v_xor_b32 v17, 112, v10
    v_lshrrev_b32 v18, 2, v1
    v_lshlrev_b32 v18, 10, v18
    v_and_b32 v19, 3, v1
    v_lshlrev_b32 v19, 4, v19
    v_or_b32 v18, v18, v19
    v_lshlrev_b32 v3, 4, v1
    s_lshl_b32 s43, s3, 13
    s_lshl_b32 s44, s40, 16
    s_add_u32 s44, s44, s43
    s_lshl_b32 s68, s40, 3
    s_add_u32 s68, s68, s41
    s_waitcnt lgkmcnt(0)
    s_mov_b32 s20, s4
    s_mov_b32 s21, s5
    s_mov_b32 s22, 0x200000
    s_mov_b32 s23, 0x00020000
    s_mov_b32 s24, s6
    s_mov_b32 s25, s7
    s_mov_b32 s26, 0x80000
    s_mov_b32 s27, 0x00020000
    s_mov_b32 s36, s62
    s_mov_b32 s37, s63
    s_mov_b32 s38, 0x1300000
    s_mov_b32 s39, 0x00020000
    s_cmp_lg_u32 s3, 7
    s_cbranch_scc1 A_NZ
    s_getreg_b32 s46, hwreg(HW_REG_XCC_ID)
    s_and_b32 s46, s46, 15
    v_mov_b32 v20, 0
    v_mov_b32 v21, s46
    v_cmp_eq_u32 vcc, 31, v1
    s_nop 1
    v_cndmask_b32 v20, v20, v21, vcc
    v_lshlrev_b32 v21, 2, v1
    s_lshl_b32 s45, s68, 7
    s_add_u32 s45, s45, 139264
    s_mov_b64 exec, 0xffffffff
    buffer_store_dword v20, v21, s[36:39], s45 offen sc1
    s_mov_b64 exec, -1
A_NZ:
    s_mov_b32 m0, s43
    s_nop 0
    buffer_load_dwordx4 v10, s[20:23], s44 offen offset:0 lds
    buffer_load_dwordx4 v11, s[20:23], s44 offen offset:1024 lds
    buffer_load_dwordx4 v12, s[20:23], s44 offen offset:2048 lds
    buffer_load_dwordx4 v13, s[20:23], s44 offen offset:3072 lds
    s_add_u32 s45, s43, 4096
    s_mov_b32 m0, s45
    s_add_u32 s44, s44, 4096
    buffer_load_dwordx4 v14, s[20:23], s44 offen offset:0 lds
    buffer_load_dwordx4 v15, s[20:23], s44 offen offset:1024 lds
    buffer_load_dwordx4 v16, s[20:23], s44 offen offset:2048 lds
    buffer_load_dwordx4 v17, s[20:23], s44 offen offset:3072 lds
    s_and_b32 s45, s41, 1
    s_cmp_eq_u32 s45, 0
    s_cselect_b32 s28, s8, s10
    s_cselect_b32 s29, s9, s11
    s_mov_b32 s30, 0x4000
    s_mov_b32 s31, 0x00020000
    s_lshl_b32 s45, s3, 11
    s_add_u32 s46, s45, 131072
    s_mov_b32 m0, s46
    s_nop 0
    buffer_load_dwordx4 v3, s[28:31], s45 offen lds
    buffer_load_dwordx4 v3, s[28:31], s45 offen offset:1024 lds
    s_lshr_b32 s45, s3, 1
    s_lshl_b32 s46, s45, 13
    s_lshl_b32 s47, s42, 15
    s_add_u32 s46, s46, s47
    s_add_u32 s46, s46, 65536
    s_lshl_b32 s47, s45, 17
    s_lshl_b32 s48, s41, 7
    s_add_u32 s47, s47, s48
    s_lshl_b32 s48, s42, 6
    s_add_u32 s47, s47, s48
    s_mov_b32 m0, s46
    s_add_u32 s46, s46, 1024
    buffer_load_dwordx4 v18, s[24:27], s47 offen lds
    s_add_u32 s47, s47, 16384
    s_mov_b32 m0, s46
    s_add_u32 s46, s46, 1024
    buffer_load_dwordx4 v18, s[24:27], s47 offen lds
    s_add_u32 s47, s47, 16384
    s_mov_b32 m0, s46
    s_add_u32 s46, s46, 1024
    buffer_load_dwordx4 v18, s[24:27], s47 offen lds
    s_add_u32 s47, s47, 16384
    s_mov_b32 m0, s46
    s_add_u32 s46, s46, 1024
    buffer_load_dwordx4 v18, s[24:27], s47 offen lds
    s_add_u32 s47, s47, 16384
    s_mov_b32 m0, s46
    s_add_u32 s46, s46, 1024
    buffer_load_dwordx4 v18, s[24:27], s47 offen lds
    s_add_u32 s47, s47, 16384
    s_mov_b32 m0, s46
    s_add_u32 s46, s46, 1024
    buffer_load_dwordx4 v18, s[24:27], s47 offen lds
    s_add_u32 s47, s47, 16384
    s_mov_b32 m0, s46
    s_add_u32 s46, s46, 1024
    buffer_load_dwordx4 v18, s[24:27], s47 offen lds
    s_add_u32 s47, s47, 16384
    s_mov_b32 m0, s46
    s_nop 0
    buffer_load_dwordx4 v18, s[24:27], s47 offen lds
    s_lshl_b32 s45, s2, 3
    s_add_u32 s45, s45, s3
    v_and_b32 v20, 31, v1
    v_lshlrev_b32 v20, 2, v20
    v_lshrrev_b32 v21, 5, v1
    s_cmp_ge_u32 s45, 1792
    s_cbranch_scc1 A_WO
    s_cmp_ge_u32 s45, 896
    s_cbranch_scc1 A_W2
    s_mov_b32 s32, s14
    s_mov_b32 s33, s15
    s_mov_b32 s34, 0x1c0000
    s_mov_b32 s35, 0x00020000
    s_lshr_b32 s46, s45, 5
    s_and_b32 s47, s45, 31
    s_lshr_b32 s48, s47, 2
    s_lshl_b32 s48, s48, 6
    s_and_b32 s49, s47, 1
    s_lshl_b32 s49, s49, 5
    s_add_u32 s48, s48, s49
    s_bfe_u32 s49, s47, 0x10001
    s_add_u32 s48, s48, s49
    s_mul_i32 s48, s48, 3584
    s_lshl_b32 s49, s46, 7
    s_add_u32 s48, s48, s49
    s_add_u32 s49, s48, 7168
    s_add_u32 s50, s48, 14336
    s_add_u32 s51, s48, 21504
    s_add_u32 s52, s48, 57344
    s_add_u32 s53, s48, 64512
    s_add_u32 s54, s48, 71680
    s_add_u32 s55, s48, 78848
    s_mov_b32 s58, 28672
    v_mul_lo_u32 v21, v21, s58
    v_add_u32 v20, v20, v21
    s_lshl_b32 s56, s46, 16
    s_lshl_b32 s57, s47, 10
    s_add_u32 s56, s56, s57
    s_add_u32 s56, s56, 4194304
    s_add_u32 s57, s56, 32768
    s_branch A_GO
A_W2:
    s_mov_b32 s32, s66
    s_mov_b32 s33, s67
    s_mov_b32 s34, 0x1c0000
    s_mov_b32 s35, 0x00020000
    s_sub_u32 s45, s45, 896
    s_lshr_b32 s46, s45, 3
    s_and_b32 s47, s45, 7
    s_lshr_b32 s48, s46, 2
    s_lshl_b32 s48, s48, 6
    s_and_b32 s49, s46, 1
    s_lshl_b32 s49, s49, 5
    s_add_u32 s48, s48, s49
    s_lshr_b32 s49, s46, 1
    s_and_b32 s49, s49, 1
    s_add_u32 s48, s48, s49
    s_lshl_b32 s48, s48, 10
    s_lshl_b32 s49, s47, 7
    s_add_u32 s48, s48, s49
    s_add_u32 s49, s48, 2048
    s_add_u32 s50, s48, 4096
    s_add_u32 s51, s48, 6144
    s_add_u32 s52, s48, 16384
    s_add_u32 s53, s48, 18432
    s_add_u32 s54, s48, 20480
    s_add_u32 s55, s48, 22528
    v_lshlrev_b32 v21, 13, v21
    v_add_u32 v20, v20, v21
    s_mul_i32 s56, s47, 112
    s_add_u32 s56, s56, s46
    s_lshl_b32 s56, s56, 11
    s_add_u32 s56, s56, 6291456
    s_add_u32 s57, s56, 1024
    s_branch A_GO
A_WO:
    s_mov_b32 s32, s12
    s_mov_b32 s33, s13
    s_mov_b32 s34, 0x80000
    s_mov_b32 s35, 0x00020000
    s_sub_u32 s45, s45, 1792
    s_lshr_b32 s46, s45, 5
    s_and_b32 s47, s45, 31
    s_lshl_b32 s48, s47, 14
    s_lshl_b32 s49, s46, 7
    s_add_u32 s48, s48, s49
    s_add_u32 s49, s48, 1024
    s_add_u32 s50, s48, 2048
    s_add_u32 s51, s48, 3072
    s_add_u32 s52, s48, 8192
    s_add_u32 s53, s48, 9216
    s_add_u32 s54, s48, 10240
    s_add_u32 s55, s48, 11264
    v_lshlrev_b32 v21, 12, v21
    v_add_u32 v20, v20, v21
    s_lshl_b32 s56, s46, 16
    s_lshl_b32 s57, s47, 10
    s_add_u32 s56, s56, s57
    s_add_u32 s56, s56, 3145728
    s_add_u32 s57, s56, 32768
A_GO:
    s_and_b32 s60, s41, 6
    s_add_u32 s60, s60, s3
    s_add_u32 s60, s60, 3
    s_and_b32 s60, s60, 7
    s_cmp_eq_u32 s3, 7
    s_cbranch_scc1 A_KV
    s_waitcnt vmcnt(8)
    s_barrier
    s_cmp_ge_u32 s3, 5
    s_cbranch_scc1 A_ST2
    buffer_load_dword v32, v20, s[32:35], s48 offen
    buffer_load_dword v33, v20, s[32:35], s49 offen
    buffer_load_dword v34, v20, s[32:35], s50 offen
    buffer_load_dword v35, v20, s[32:35], s51 offen
    buffer_load_dword v36, v20, s[32:35], s52 offen
    buffer_load_dword v37, v20, s[32:35], s53 offen
    buffer_load_dword v38, v20, s[32:35], s54 offen
    buffer_load_dword v39, v20, s[32:35], s55 offen
    s_barrier
    v_lshrrev_b32 v2, 3, v1
    v_and_b32 v14, 7, v1
    v_and_b32 v4, 1, v2
    v_lshlrev_b32 v5, 10, v2
    v_lshl_add_u32 v5, v14, 4, v5
    s_lshl_b32 s45, s60, 13
    v_add_u32 v5, s45, v5
    v_lshlrev_b32 v4, 7, v4
    v_add_u32 v6, v5, v4
    v_xor_b32 v4, 128, v4
    v_add_u32 v7, v5, v4
    ds_read_b128 v[52:55], v6 offset:0
    ds_read_b128 v[56:59], v7 offset:0
    ds_read_b128 v[60:63], v6 offset:256
    ds_read_b128 v[64:67], v7 offset:256
    ds_read_b128 v[68:71], v6 offset:512
    ds_read_b128 v[72:75], v7 offset:512
    ds_read_b128 v[76:79], v6 offset:768
    ds_read_b128 v[80:83], v7 offset:768
    v_mov_b32 v8, 0x3f803f80
    v_mov_b32 v84, 0
    v_mov_b32 v85, 0
    v_mov_b32 v86, 0
    v_mov_b32 v87, 0
    v_mov_b32 v88, 0
    v_mov_b32 v89, 0
    v_mov_b32 v90, 0
    v_mov_b32 v91, 0
    s_waitcnt lgkmcnt(7)
    v_dot2c_f32_bf16 v84, v52, v8
    v_dot2c_f32_bf16 v88, v52, v52
    v_dot2c_f32_bf16 v85, v53, v8
    v_dot2c_f32_bf16 v89, v53, v53
    v_dot2c_f32_bf16 v86, v54, v8
    v_dot2c_f32_bf16 v90, v54, v54
    v_dot2c_f32_bf16 v87, v55, v8
    v_dot2c_f32_bf16 v91, v55, v55
    s_waitcnt lgkmcnt(6)
    v_dot2c_f32_bf16 v84, v56, v8
    v_dot2c_f32_bf16 v88, v56, v56
    v_dot2c_f32_bf16 v85, v57, v8
    v_dot2c_f32_bf16 v89, v57, v57
    v_dot2c_f32_bf16 v86, v58, v8
    v_dot2c_f32_bf16 v90, v58, v58
    v_dot2c_f32_bf16 v87, v59, v8
    v_dot2c_f32_bf16 v91, v59, v59
    s_waitcnt lgkmcnt(5)
    v_dot2c_f32_bf16 v84, v60, v8
    v_dot2c_f32_bf16 v88, v60, v60
    v_dot2c_f32_bf16 v85, v61, v8
    v_dot2c_f32_bf16 v89, v61, v61
    v_dot2c_f32_bf16 v86, v62, v8
    v_dot2c_f32_bf16 v90, v62, v62
    v_dot2c_f32_bf16 v87, v63, v8
    v_dot2c_f32_bf16 v91, v63, v63
    s_waitcnt lgkmcnt(4)
    v_dot2c_f32_bf16 v84, v64, v8
    v_dot2c_f32_bf16 v88, v64, v64
    v_dot2c_f32_bf16 v85, v65, v8
    v_dot2c_f32_bf16 v89, v65, v65
    v_dot2c_f32_bf16 v86, v66, v8
    v_dot2c_f32_bf16 v90, v66, v66
    v_dot2c_f32_bf16 v87, v67, v8
    v_dot2c_f32_bf16 v91, v67, v67
    s_waitcnt lgkmcnt(3)
    v_dot2c_f32_bf16 v84, v68, v8
    v_dot2c_f32_bf16 v88, v68, v68
    v_dot2c_f32_bf16 v85, v69, v8
    v_dot2c_f32_bf16 v89, v69, v69
    v_dot2c_f32_bf16 v86, v70, v8
    v_dot2c_f32_bf16 v90, v70, v70
    v_dot2c_f32_bf16 v87, v71, v8
    v_dot2c_f32_bf16 v91, v71, v71
    s_waitcnt lgkmcnt(2)
    v_dot2c_f32_bf16 v84, v72, v8
    v_dot2c_f32_bf16 v88, v72, v72
    v_dot2c_f32_bf16 v85, v73, v8
    v_dot2c_f32_bf16 v89, v73, v73
    v_dot2c_f32_bf16 v86, v74, v8
    v_dot2c_f32_bf16 v90, v74, v74
    v_dot2c_f32_bf16 v87, v75, v8
    v_dot2c_f32_bf16 v91, v75, v75
    s_waitcnt lgkmcnt(1)
    v_dot2c_f32_bf16 v84, v76, v8
    v_dot2c_f32_bf16 v88, v76, v76
    v_dot2c_f32_bf16 v85, v77, v8
    v_dot2c_f32_bf16 v89, v77, v77
    v_dot2c_f32_bf16 v86, v78, v8
    v_dot2c_f32_bf16 v90, v78, v78
    v_dot2c_f32_bf16 v87, v79, v8
    v_dot2c_f32_bf16 v91, v79, v79
    s_waitcnt lgkmcnt(0)
    v_dot2c_f32_bf16 v84, v80, v8
    v_dot2c_f32_bf16 v88, v80, v80
    v_dot2c_f32_bf16 v85, v81, v8
    v_dot2c_f32_bf16 v89, v81, v81
    v_dot2c_f32_bf16 v86, v82, v8
    v_dot2c_f32_bf16 v90, v82, v82
    v_dot2c_f32_bf16 v87, v83, v8
    v_dot2c_f32_bf16 v91, v83, v83
    v_add_f32 v84, v84, v85
    s_nop 0
    v_add_f32 v86, v86, v87
    v_add_f32 v88, v88, v89
    v_add_f32 v90, v90, v91
    v_add_f32 v84, v84, v86
    v_add_f32 v88, v88, v90
    s_nop 0
    v_add_f32_dpp v84, v84, v84 quad_perm:[1,0,3,2] row_mask:0xf bank_mask:0xf
    v_add_f32_dpp v88, v88, v88 quad_perm:[1,0,3,2] row_mask:0xf bank_mask:0xf
    s_nop 0
    v_add_f32_dpp v84, v84, v84 quad_perm:[2,3,0,1] row_mask:0xf bank_mask:0xf
    v_add_f32_dpp v88, v88, v88 quad_perm:[2,3,0,1] row_mask:0xf bank_mask:0xf
    s_nop 0
    v_add_f32_dpp v84, v84, v84 row_half_mirror row_mask:0xf bank_mask:0xf
    v_add_f32_dpp v88, v88, v88 row_half_mirror row_mask:0xf bank_mask:0xf
    v_mul_f32 v84, 0x3b000000, v84
    v_mul_f32 v88, 0x3b000000, v88
    v_fma_f32 v88, -v84, v84, v88
    v_max_f32 v88, 0, v88
    v_add_f32 v88, 0x3727c5ac, v88
    v_rsq_f32 v88, v88
    s_nop 0
    v_mul_f32 v89, v84, v88
    v_sub_f32 v89, 0, v89
    v_lshlrev_b32 v5, 3, v2
    s_lshl_b32 s45, s60, 6
    s_add_u32 s45, s45, 147456
    v_add_u32 v5, s45, v5
    ds_write_b64 v5, v[88:89]
    s_branch A_ST3
A_ST2:
    v_lshrrev_b32 v2, 3, v1
    v_and_b32 v14, 7, v1
    v_and_b32 v4, 1, v2
    v_lshlrev_b32 v5, 10, v2
    v_lshl_add_u32 v5, v14, 4, v5
    s_lshl_b32 s45, s60, 13
    v_add_u32 v5, s45, v5
    v_lshlrev_b32 v4, 7, v4
    v_add_u32 v6, v5, v4
    v_xor_b32 v4, 128, v4
    v_add_u32 v7, v5, v4
    ds_read_b128 v[52:55], v6 offset:0
    ds_read_b128 v[56:59], v7 offset:0
    ds_read_b128 v[60:63], v6 offset:256
    ds_read_b128 v[64:67], v7 offset:256
    ds_read_b128 v[68:71], v6 offset:512
    ds_read_b128 v[72:75], v7 offset:512
    ds_read_b128 v[76:79], v6 offset:768
    ds_read_b128 v[80:83], v7 offset:768
    v_mov_b32 v8, 0x3f803f80
    v_mov_b32 v84, 0
    v_mov_b32 v85, 0
    v_mov_b32 v86, 0
    v_mov_b32 v87, 0
    v_mov_b32 v88, 0
    v_mov_b32 v89, 0
    v_mov_b32 v90, 0
    v_mov_b32 v91, 0
    s_waitcnt lgkmcnt(7)
    v_dot2c_f32_bf16 v84, v52, v8
    v_dot2c_f32_bf16 v88, v52, v52
    v_dot2c_f32_bf16 v85, v53, v8
    v_dot2c_f32_bf16 v89, v53, v53
    v_dot2c_f32_bf16 v86, v54, v8
    v_dot2c_f32_bf16 v90, v54, v54
    v_dot2c_f32_bf16 v87, v55, v8
    v_dot2c_f32_bf16 v91, v55, v55
    s_waitcnt lgkmcnt(6)
    v_dot2c_f32_bf16 v84, v56, v8
    v_dot2c_f32_bf16 v88, v56, v56
    v_dot2c_f32_bf16 v85, v57, v8
    v_dot2c_f32_bf16 v89, v57, v57
    v_dot2c_f32_bf16 v86, v58, v8
    v_dot2c_f32_bf16 v90, v58, v58
    v_dot2c_f32_bf16 v87, v59, v8
    v_dot2c_f32_bf16 v91, v59, v59
    s_waitcnt lgkmcnt(5)
    v_dot2c_f32_bf16 v84, v60, v8
    v_dot2c_f32_bf16 v88, v60, v60
    v_dot2c_f32_bf16 v85, v61, v8
    v_dot2c_f32_bf16 v89, v61, v61
    v_dot2c_f32_bf16 v86, v62, v8
    v_dot2c_f32_bf16 v90, v62, v62
    v_dot2c_f32_bf16 v87, v63, v8
    v_dot2c_f32_bf16 v91, v63, v63
    s_waitcnt lgkmcnt(4)
    v_dot2c_f32_bf16 v84, v64, v8
    v_dot2c_f32_bf16 v88, v64, v64
    v_dot2c_f32_bf16 v85, v65, v8
    v_dot2c_f32_bf16 v89, v65, v65
    v_dot2c_f32_bf16 v86, v66, v8
    v_dot2c_f32_bf16 v90, v66, v66
    v_dot2c_f32_bf16 v87, v67, v8
    v_dot2c_f32_bf16 v91, v67, v67
    s_waitcnt lgkmcnt(3)
    v_dot2c_f32_bf16 v84, v68, v8
    v_dot2c_f32_bf16 v88, v68, v68
    v_dot2c_f32_bf16 v85, v69, v8
    v_dot2c_f32_bf16 v89, v69, v69
    v_dot2c_f32_bf16 v86, v70, v8
    v_dot2c_f32_bf16 v90, v70, v70
    v_dot2c_f32_bf16 v87, v71, v8
    v_dot2c_f32_bf16 v91, v71, v71
    s_waitcnt lgkmcnt(2)
    v_dot2c_f32_bf16 v84, v72, v8
    v_dot2c_f32_bf16 v88, v72, v72
    v_dot2c_f32_bf16 v85, v73, v8
    v_dot2c_f32_bf16 v89, v73, v73
    v_dot2c_f32_bf16 v86, v74, v8
    v_dot2c_f32_bf16 v90, v74, v74
    v_dot2c_f32_bf16 v87, v75, v8
    v_dot2c_f32_bf16 v91, v75, v75
    s_waitcnt lgkmcnt(1)
    v_dot2c_f32_bf16 v84, v76, v8
    v_dot2c_f32_bf16 v88, v76, v76
    v_dot2c_f32_bf16 v85, v77, v8
    v_dot2c_f32_bf16 v89, v77, v77
    v_dot2c_f32_bf16 v86, v78, v8
    v_dot2c_f32_bf16 v90, v78, v78
    v_dot2c_f32_bf16 v87, v79, v8
    v_dot2c_f32_bf16 v91, v79, v79
    s_waitcnt lgkmcnt(0)
    v_dot2c_f32_bf16 v84, v80, v8
    v_dot2c_f32_bf16 v88, v80, v80
    v_dot2c_f32_bf16 v85, v81, v8
    v_dot2c_f32_bf16 v89, v81, v81
    v_dot2c_f32_bf16 v86, v82, v8
    v_dot2c_f32_bf16 v90, v82, v82
    v_dot2c_f32_bf16 v87, v83, v8
    v_dot2c_f32_bf16 v91, v83, v83
    v_add_f32 v84, v84, v85
    s_nop 0
    v_add_f32 v86, v86, v87
    v_add_f32 v88, v88, v89
    v_add_f32 v90, v90, v91
    v_add_f32 v84, v84, v86
    v_add_f32 v88, v88, v90
    s_nop 0
    v_add_f32_dpp v84, v84, v84 quad_perm:[1,0,3,2] row_mask:0xf bank_mask:0xf
    v_add_f32_dpp v88, v88, v88 quad_perm:[1,0,3,2] row_mask:0xf bank_mask:0xf
    s_nop 0
    v_add_f32_dpp v84, v84, v84 quad_perm:[2,3,0,1] row_mask:0xf bank_mask:0xf
    v_add_f32_dpp v88, v88, v88 quad_perm:[2,3,0,1] row_mask:0xf bank_mask:0xf
    s_nop 0
    v_add_f32_dpp v84, v84, v84 row_half_mirror row_mask:0xf bank_mask:0xf
    v_add_f32_dpp v88, v88, v88 row_half_mirror row_mask:0xf bank_mask:0xf
    v_mul_f32 v84, 0x3b000000, v84
    v_mul_f32 v88, 0x3b000000, v88
    v_fma_f32 v88, -v84, v84, v88
    v_max_f32 v88, 0, v88
    v_add_f32 v88, 0x3727c5ac, v88
    v_rsq_f32 v88, v88
    s_nop 0
    v_mul_f32 v89, v84, v88
    v_sub_f32 v89, 0, v89
    v_lshlrev_b32 v5, 3, v2
    s_lshl_b32 s45, s60, 6
    s_add_u32 s45, s45, 147456
    v_add_u32 v5, s45, v5
    ds_write_b64 v5, v[88:89]
    s_waitcnt lgkmcnt(0)
    s_barrier
    buffer_load_dword v32, v20, s[32:35], s48 offen
    buffer_load_dword v33, v20, s[32:35], s49 offen
    buffer_load_dword v34, v20, s[32:35], s50 offen
    buffer_load_dword v35, v20, s[32:35], s51 offen
    buffer_load_dword v36, v20, s[32:35], s52 offen
    buffer_load_dword v37, v20, s[32:35], s53 offen
    buffer_load_dword v38, v20, s[32:35], s54 offen
    buffer_load_dword v39, v20, s[32:35], s55 offen
A_ST3:
    v_and_b32 v2, 31, v1
    v_lshrrev_b32 v28, 5, v1
    s_lshr_b32 s45, s3, 2
    s_lshl_b32 s45, s45, 2
    s_lshl_b32 s61, s41, 3
    s_add_u32 s45, s45, s61
    v_add_u32 v4, s45, v28
    v_and_b32 v5, 15, v2
    v_xor_b32 v4, v4, v5
    v_lshlrev_b32 v4, 4, v4
    v_lshl_add_u32 v4, v2, 10, v4
    s_bfe_u32 s61, s3, 0x10001
    s_lshl_b32 s61, s61, 15
    v_add_u32 v4, s61, v4
    v_xor_b32 v5, 32, v4
    ds_read_b128 v[16:19], v4
    ds_read_b128 v[20:23], v5
    s_waitcnt lgkmcnt(0)
    s_waitcnt vmcnt(8)
    s_barrier
    s_cmp_ge_u32 s3, 4
    s_cbranch_scc1 A_AUX
    v_and_b32 v4, 15, v2
    v_xor_b32 v4, v4, v28
    v_lshlrev_b32 v4, 4, v4
    s_lshr_b32 s45, s3, 1
    s_lshl_b32 s46, s45, 15
    v_lshl_add_u32 v4, v2, 10, v4
    v_add_u32 v40, s46, v4
    v_xor_b32 v41, 32, v40
    v_xor_b32 v42, 64, v40
    v_xor_b32 v43, 96, v40
    v_xor_b32 v44, 128, v40
    v_xor_b32 v45, 160, v40
    v_xor_b32 v46, 192, v40
    v_xor_b32 v47, 224, v40
    v_lshrrev_b32 v5, 5, v1
    v_lshlrev_b32 v5, 9, v5
    v_bfe_u32 v6, v1, 2, 2
    v_lshl_add_u32 v5, v6, 6, v5
    v_bfe_u32 v6, v1, 4, 1
    v_lshl_add_u32 v5, v6, 5, v5
    v_and_b32 v6, 3, v1
    v_lshl_add_u32 v5, v6, 3, v5
    s_lshl_b32 s46, s42, 15
    s_add_u32 s46, s46, 65536
    v_add_u32 v48, s46, v5
    v_mov_b32 v100, 0
    v_mov_b32 v101, 0
    v_mov_b32 v102, 0
    v_mov_b32 v103, 0
    v_mov_b32 v104, 0
    v_mov_b32 v105, 0
    v_mov_b32 v106, 0
    v_mov_b32 v107, 0
    v_mov_b32 v108, 0
    v_mov_b32 v109, 0
    v_mov_b32 v110, 0
    v_mov_b32 v111, 0
    v_mov_b32 v112, 0
    v_mov_b32 v113, 0
    v_mov_b32 v114, 0
    v_mov_b32 v115, 0
    ds_read_b64_tr_b16 v[52:53], v48 offset:0
    ds_read_b64_tr_b16 v[54:55], v48 offset:256
    ds_read_b128 v[56:59], v40 offset:0
    ds_read_b64_tr_b16 v[60:61], v48 offset:1024
    ds_read_b64_tr_b16 v[62:63], v48 offset:1280
    ds_read_b128 v[64:67], v41 offset:0
    ds_read_b64_tr_b16 v[68:69], v48 offset:2048
    ds_read_b64_tr_b16 v[70:71], v48 offset:2304
    ds_read_b128 v[72:75], v42 offset:0
    ds_read_b64_tr_b16 v[76:77], v48 offset:3072
    ds_read_b64_tr_b16 v[78:79], v48 offset:3328
    ds_read_b128 v[80:83], v43 offset:0
    s_waitcnt lgkmcnt(9)
    v_mfma_f32_32x32x16_bf16 v[100:115], v[52:55], v[56:59], v[100:115]
    ds_read_b64_tr_b16 v[52:53], v48 offset:4096
    ds_read_b64_tr_b16 v[54:55], v48 offset:4352
    ds_read_b128 v[56:59], v44 offset:0
    s_waitcnt lgkmcnt(9)
    v_mfma_f32_32x32x16_bf16 v[100:115], v[60:63], v[64:67], v[100:115]
    ds_read_b64_tr_b16 v[60:61], v48 offset:5120
    ds_read_b64_tr_b16 v[62:63], v48 offset:5376
    ds_read_b128 v[64:67], v45 offset:0
    s_waitcnt lgkmcnt(9)
    v_mfma_f32_32x32x16_bf16 v[100:115], v[68:71], v[72:75], v[100:115]
    ds_read_b64_tr_b16 v[68:69], v48 offset:6144
    ds_read_b64_tr_b16 v[70:71], v48 offset:6400
    ds_read_b128 v[72:75], v46 offset:0
    s_waitcnt lgkmcnt(9)
    v_mfma_f32_32x32x16_bf16 v[100:115], v[76:79], v[80:83], v[100:115]
    ds_read_b64_tr_b16 v[76:77], v48 offset:7168
    ds_read_b64_tr_b16 v[78:79], v48 offset:7424
    ds_read_b128 v[80:83], v47 offset:0
    s_waitcnt lgkmcnt(9)
    v_mfma_f32_32x32x16_bf16 v[100:115], v[52:55], v[56:59], v[100:115]
    ds_read_b64_tr_b16 v[52:53], v48 offset:8192
    ds_read_b64_tr_b16 v[54:55], v48 offset:8448
    ds_read_b128 v[56:59], v40 offset:256
    s_waitcnt lgkmcnt(9)
    v_mfma_f32_32x32x16_bf16 v[100:115], v[60:63], v[64:67], v[100:115]
    ds_read_b64_tr_b16 v[60:61], v48 offset:9216
    ds_read_b64_tr_b16 v[62:63], v48 offset:9472
    ds_read_b128 v[64:67], v41 offset:256
    s_waitcnt lgkmcnt(9)
    v_mfma_f32_32x32x16_bf16 v[100:115], v[68:71], v[72:75], v[100:115]
    ds_read_b64_tr_b16 v[68:69], v48 offset:10240
    ds_read_b64_tr_b16 v[70:71], v48 offset:10496
    ds_read_b128 v[72:75], v42 offset:256
    s_waitcnt lgkmcnt(9)
    v_mfma_f32_32x32x16_bf16 v[100:115], v[76:79], v[80:83], v[100:115]
    ds_read_b64_tr_b16 v[76:77], v48 offset:11264
    ds_read_b64_tr_b16 v[78:79], v48 offset:11520
    ds_read_b128 v[80:83], v43 offset:256
    s_waitcnt lgkmcnt(9)
    v_mfma_f32_32x32x16_bf16 v[100:115], v[52:55], v[56:59], v[100:115]
    ds_read_b64_tr_b16 v[52:53], v48 offset:12288
    ds_read_b64_tr_b16 v[54:55], v48 offset:12544
    ds_read_b128 v[56:59], v44 offset:256
    s_waitcnt lgkmcnt(9)
    v_mfma_f32_32x32x16_bf16 v[100:115], v[60:63], v[64:67], v[100:115]
    ds_read_b64_tr_b16 v[60:61], v48 offset:13312
    ds_read_b64_tr_b16 v[62:63], v48 offset:13568
    ds_read_b128 v[64:67], v45 offset:256
    s_waitcnt lgkmcnt(9)
    v_mfma_f32_32x32x16_bf16 v[100:115], v[68:71], v[72:75], v[100:115]
    ds_read_b64_tr_b16 v[68:69], v48 offset:14336
    ds_read_b64_tr_b16 v[70:71], v48 offset:14592
    ds_read_b128 v[72:75], v46 offset:256
    s_waitcnt lgkmcnt(9)
    v_mfma_f32_32x32x16_bf16 v[100:115], v[76:79], v[80:83], v[100:115]
    ds_read_b64_tr_b16 v[76:77], v48 offset:15360
    ds_read_b64_tr_b16 v[78:79], v48 offset:15616
    ds_read_b128 v[80:83], v47 offset:256
    s_waitcnt lgkmcnt(9)
    v_mfma_f32_32x32x16_bf16 v[100:115], v[52:55], v[56:59], v[100:115]
    ds_read_b64_tr_b16 v[52:53], v48 offset:16384
    ds_read_b64_tr_b16 v[54:55], v48 offset:16640
    ds_read_b128 v[56:59], v40 offset:512
    s_waitcnt lgkmcnt(9)
    v_mfma_f32_32x32x16_bf16 v[100:115], v[60:63], v[64:67], v[100:115]
    ds_read_b64_tr_b16 v[60:61], v48 offset:17408
    ds_read_b64_tr_b16 v[62:63], v48 offset:17664
    ds_read_b128 v[64:67], v41 offset:512
    s_waitcnt lgkmcnt(9)
    v_mfma_f32_32x32x16_bf16 v[100:115], v[68:71], v[72:75], v[100:115]
    ds_read_b64_tr_b16 v[68:69], v48 offset:18432
    ds_read_b64_tr_b16 v[70:71], v48 offset:18688
    ds_read_b128 v[72:75], v42 offset:512
    s_waitcnt lgkmcnt(9)
    v_mfma_f32_32x32x16_bf16 v[100:115], v[76:79], v[80:83], v[100:115]
    ds_read_b64_tr_b16 v[76:77], v48 offset:19456
    ds_read_b64_tr_b16 v[78:79], v48 offset:19712
    ds_read_b128 v[80:83], v43 offset:512
    s_waitcnt lgkmcnt(9)
    v_mfma_f32_32x32x16_bf16 v[100:115], v[52:55], v[56:59], v[100:115]
    ds_read_b64_tr_b16 v[52:53], v48 offset:20480
    ds_read_b64_tr_b16 v[54:55], v48 offset:20736
    ds_read_b128 v[56:59], v44 offset:512
    s_waitcnt lgkmcnt(9)
    v_mfma_f32_32x32x16_bf16 v[100:115], v[60:63], v[64:67], v[100:115]
    ds_read_b64_tr_b16 v[60:61], v48 offset:21504
    ds_read_b64_tr_b16 v[62:63], v48 offset:21760
    ds_read_b128 v[64:67], v45 offset:512
    s_waitcnt lgkmcnt(9)
    v_mfma_f32_32x32x16_bf16 v[100:115], v[68:71], v[72:75], v[100:115]
    ds_read_b64_tr_b16 v[68:69], v48 offset:22528
    ds_read_b64_tr_b16 v[70:71], v48 offset:22784
    ds_read_b128 v[72:75], v46 offset:512
    s_waitcnt lgkmcnt(9)
    v_mfma_f32_32x32x16_bf16 v[100:115], v[76:79], v[80:83], v[100:115]
    ds_read_b64_tr_b16 v[76:77], v48 offset:23552
    ds_read_b64_tr_b16 v[78:79], v48 offset:23808
    ds_read_b128 v[80:83], v47 offset:512
    s_waitcnt lgkmcnt(9)
    v_mfma_f32_32x32x16_bf16 v[100:115], v[52:55], v[56:59], v[100:115]
    ds_read_b64_tr_b16 v[52:53], v48 offset:24576
    ds_read_b64_tr_b16 v[54:55], v48 offset:24832
    ds_read_b128 v[56:59], v40 offset:768
    s_waitcnt lgkmcnt(9)
    v_mfma_f32_32x32x16_bf16 v[100:115], v[60:63], v[64:67], v[100:115]
    ds_read_b64_tr_b16 v[60:61], v48 offset:25600
    ds_read_b64_tr_b16 v[62:63], v48 offset:25856
    ds_read_b128 v[64:67], v41 offset:768
    s_waitcnt lgkmcnt(9)
    v_mfma_f32_32x32x16_bf16 v[100:115], v[68:71], v[72:75], v[100:115]
    ds_read_b64_tr_b16 v[68:69], v48 offset:26624
    ds_read_b64_tr_b16 v[70:71], v48 offset:26880
    ds_read_b128 v[72:75], v42 offset:768
    s_waitcnt lgkmcnt(9)
    v_mfma_f32_32x32x16_bf16 v[100:115], v[76:79], v[80:83], v[100:115]
    ds_read_b64_tr_b16 v[76:77], v48 offset:27648
    ds_read_b64_tr_b16 v[78:79], v48 offset:27904
    ds_read_b128 v[80:83], v43 offset:768
    s_waitcnt lgkmcnt(9)
    v_mfma_f32_32x32x16_bf16 v[100:115], v[52:55], v[56:59], v[100:115]
    ds_read_b64_tr_b16 v[52:53], v48 offset:28672
    ds_read_b64_tr_b16 v[54:55], v48 offset:28928
    ds_read_b128 v[56:59], v44 offset:768
    s_waitcnt lgkmcnt(9)
    v_mfma_f32_32x32x16_bf16 v[100:115], v[60:63], v[64:67], v[100:115]
    ds_read_b64_tr_b16 v[60:61], v48 offset:29696
    ds_read_b64_tr_b16 v[62:63], v48 offset:29952
    ds_read_b128 v[64:67], v45 offset:768
    s_waitcnt lgkmcnt(9)
    v_mfma_f32_32x32x16_bf16 v[100:115], v[68:71], v[72:75], v[100:115]
    ds_read_b64_tr_b16 v[68:69], v48 offset:30720
    ds_read_b64_tr_b16 v[70:71], v48 offset:30976
    ds_read_b128 v[72:75], v46 offset:768
    s_waitcnt lgkmcnt(9)
    v_mfma_f32_32x32x16_bf16 v[100:115], v[76:79], v[80:83], v[100:115]
    ds_read_b64_tr_b16 v[76:77], v48 offset:31744
    ds_read_b64_tr_b16 v[78:79], v48 offset:32000
    ds_read_b128 v[80:83], v47 offset:768
    s_waitcnt lgkmcnt(9)
    v_mfma_f32_32x32x16_bf16 v[100:115], v[52:55], v[56:59], v[100:115]
    s_waitcnt lgkmcnt(6)
    v_mfma_f32_32x32x16_bf16 v[100:115], v[60:63], v[64:67], v[100:115]
    s_waitcnt lgkmcnt(3)
    v_mfma_f32_32x32x16_bf16 v[100:115], v[68:71], v[72:75], v[100:115]
    s_waitcnt lgkmcnt(0)
    v_mfma_f32_32x32x16_bf16 v[100:115], v[76:79], v[80:83], v[100:115]
    s_barrier
    s_lshl_b32 s46, s45, 8
    s_add_u32 s46, s46, 147456
    v_lshlrev_b32 v5, 3, v2
    v_add_u32 v5, s46, v5
    ds_read_b64 v[52:53], v5
    s_lshl_b32 s46, s42, 7
    s_add_u32 s46, s46, 147968
    v_lshlrev_b32 v5, 4, v28
    v_add_u32 v5, s46, v5
    ds_read_b128 v[56:59], v5 offset:0
    ds_read_b128 v[60:63], v5 offset:32
    ds_read_b128 v[64:67], v5 offset:64
    ds_read_b128 v[68:71], v5 offset:96
    s_mov_b32 s46, 0x3eb8aa3b
    s_waitcnt lgkmcnt(0)
    v_mul_f32 v52, s46, v52
    v_mul_f32 v53, s46, v53
    v_mul_f32 v56, v53, v56
    v_mul_f32 v57, v53, v57
    v_mul_f32 v58, v53, v58
    v_mul_f32 v59, v53, v59
    v_mul_f32 v60, v53, v60
    v_mul_f32 v61, v53, v61
    v_mul_f32 v62, v53, v62
    v_mul_f32 v63, v53, v63
    v_mul_f32 v64, v53, v64
    v_mul_f32 v65, v53, v65
    v_mul_f32 v66, v53, v66
    v_mul_f32 v67, v53, v67
    v_mul_f32 v68, v53, v68
    v_mul_f32 v69, v53, v69
    v_mul_f32 v70, v53, v70
    v_mul_f32 v71, v53, v71
    v_fma_f32 v100, v52, v100, v56
    v_fma_f32 v101, v52, v101, v57
    v_fma_f32 v102, v52, v102, v58
    v_fma_f32 v103, v52, v103, v59
    v_fma_f32 v104, v52, v104, v60
    v_fma_f32 v105, v52, v105, v61
    v_fma_f32 v106, v52, v106, v62
    v_fma_f32 v107, v52, v107, v63
    v_fma_f32 v108, v52, v108, v64
    v_fma_f32 v109, v52, v109, v65
    v_fma_f32 v110, v52, v110, v66
    v_fma_f32 v111, v52, v111, v67
    v_fma_f32 v112, v52, v112, v68
    v_fma_f32 v113, v52, v113, v69
    v_fma_f32 v114, v52, v114, v70
    v_fma_f32 v115, v52, v115, v71
    v_cvt_pk_bf16_f32 v80, v108, v109
    v_cvt_pk_bf16_f32 v81, v110, v111
    v_cvt_pk_bf16_f32 v82, v112, v113
    v_cvt_pk_bf16_f32 v83, v114, v115
    s_lshl_b32 s46, s3, 10
    v_add_u32 v5, s46, v3
    ds_write_b128 v5, v[80:83] offset:0
    v_cvt_pk_bf16_f32 v24, v100, v101
    v_cvt_pk_bf16_f32 v25, v102, v103
    v_cvt_pk_bf16_f32 v26, v104, v105
    v_cvt_pk_bf16_f32 v27, v106, v107
    v_mul_f32 v54, v100, v100
    v_mul_f32 v55, v108, v108
    v_fmac_f32 v54, v101, v101
    v_fmac_f32 v55, v109, v109
    v_fmac_f32 v54, v102, v102
    v_fmac_f32 v55, v110, v110
    v_fmac_f32 v54, v103, v103
    v_fmac_f32 v55, v111, v111
    v_fmac_f32 v54, v104, v104
    v_fmac_f32 v55, v112, v112
    v_fmac_f32 v54, v105, v105
    v_fmac_f32 v55, v113, v113
    v_fmac_f32 v54, v106, v106
    v_fmac_f32 v55, v114, v114
    v_fmac_f32 v54, v107, v107
    v_fmac_f32 v55, v115, v115
    v_mov_b32 v56, v54
    v_mov_b32 v57, v55
    s_nop 0
    v_permlane32_swap_b32 v54, v56
    v_permlane32_swap_b32 v55, v57
    v_add_f32 v54, v54, v56
    v_add_f32 v55, v55, v57
    v_max_f32 v54, v54, v55
    s_nop 1
    v_max_f32_dpp v54, v54, v54 row_ror:8 row_mask:0xf bank_mask:0xf
    s_nop 1
    v_max_f32_dpp v54, v54, v54 row_ror:4 row_mask:0xf bank_mask:0xf
    s_nop 1
    v_max_f32_dpp v54, v54, v54 row_ror:2 row_mask:0xf bank_mask:0xf
    s_nop 1
    v_max_f32_dpp v54, v54, v54 row_ror:1 row_mask:0xf bank_mask:0xf
    v_mov_b32 v56, v54
    s_nop 1
    v_permlane16_swap_b32 v54, v56
    v_max_f32 v54, v54, v56
    v_mov_b32 v56, v54
    s_nop 1
    v_permlane32_swap_b32 v54, v56
    v_max_f32 v54, v54, v56
    s_lshl_b32 s46, s3, 2
    s_add_u32 s46, s46, 148240
    v_mov_b32 v5, s46
    ds_write_b32 v5, v54
    s_waitcnt vmcnt(0)
    s_mov_b32 s58, 0x05040100
    s_mov_b32 s59, 0x07060302
    v_perm_b32 v40, v33, v32, s58
    v_perm_b32 v44, v33, v32, s59
    v_perm_b32 v41, v35, v34, s58
    v_perm_b32 v45, v35, v34, s59
    v_perm_b32 v42, v37, v36, s58
    v_perm_b32 v46, v37, v36, s59
    v_perm_b32 v43, v39, v38, s58
    v_perm_b32 v47, v39, v38, s59
    buffer_store_dwordx4 v[40:43], v3, s[36:39], s56 offen sc1
    buffer_store_dwordx4 v[44:47], v3, s[36:39], s57 offen sc1
    s_branch A_B4
A_AUX:
    s_sub_u32 s45, s3, 4
    v_mov_b32 v44, 0x3f803f80
    v_mov_b32 v45, 0x3f803f80
    v_mov_b32 v46, 0x3f803f80
    v_mov_b32 v47, 0x3f803f80
A_CS:
    v_lshrrev_b32 v5, 4, v1
    v_lshlrev_b32 v5, 9, v5
    v_bfe_u32 v6, v1, 2, 2
    v_lshl_add_u32 v5, v6, 6, v5
    v_and_b32 v6, 3, v1
    v_lshl_add_u32 v5, v6, 3, v5
    s_lshr_b32 s46, s45, 1
    s_lshl_b32 s46, s46, 15
    s_and_b32 s47, s45, 1
    s_lshl_b32 s47, s47, 5
    s_add_u32 s46, s46, s47
    s_add_u32 s46, s46, 65536
    v_add_u32 v48, s46, v5
    v_mov_b32 v100, 0
    v_mov_b32 v101, 0
    v_mov_b32 v102, 0
    v_mov_b32 v103, 0
    ds_read_b64_tr_b16 v[52:53], v48 offset:0
    ds_read_b64_tr_b16 v[54:55], v48 offset:256
    ds_read_b64_tr_b16 v[56:57], v48 offset:2048
    ds_read_b64_tr_b16 v[58:59], v48 offset:2304
    ds_read_b64_tr_b16 v[60:61], v48 offset:4096
    ds_read_b64_tr_b16 v[62:63], v48 offset:4352
    ds_read_b64_tr_b16 v[64:65], v48 offset:6144
    ds_read_b64_tr_b16 v[66:67], v48 offset:6400
    ds_read_b64_tr_b16 v[68:69], v48 offset:8192
    ds_read_b64_tr_b16 v[70:71], v48 offset:8448
    ds_read_b64_tr_b16 v[72:73], v48 offset:10240
    ds_read_b64_tr_b16 v[74:75], v48 offset:10496
    s_waitcnt lgkmcnt(10)
    v_mfma_f32_16x16x32_bf16 v[100:103], v[52:55], v[44:47], v[100:103]
    ds_read_b64_tr_b16 v[52:53], v48 offset:12288
    ds_read_b64_tr_b16 v[54:55], v48 offset:12544
    s_waitcnt lgkmcnt(10)
    v_mfma_f32_16x16x32_bf16 v[100:103], v[56:59], v[44:47], v[100:103]
    ds_read_b64_tr_b16 v[56:57], v48 offset:14336
    ds_read_b64_tr_b16 v[58:59], v48 offset:14592
    s_waitcnt lgkmcnt(10)
    v_mfma_f32_16x16x32_bf16 v[100:103], v[60:63], v[44:47], v[100:103]
    ds_read_b64_tr_b16 v[60:61], v48 offset:16384
    ds_read_b64_tr_b16 v[62:63], v48 offset:16640
    s_waitcnt lgkmcnt(10)
    v_mfma_f32_16x16x32_bf16 v[100:103], v[64:67], v[44:47], v[100:103]
    ds_read_b64_tr_b16 v[64:65], v48 offset:18432
    ds_read_b64_tr_b16 v[66:67], v48 offset:18688
    s_waitcnt lgkmcnt(10)
    v_mfma_f32_16x16x32_bf16 v[100:103], v[68:71], v[44:47], v[100:103]
    ds_read_b64_tr_b16 v[68:69], v48 offset:20480
    ds_read_b64_tr_b16 v[70:71], v48 offset:20736
    s_waitcnt lgkmcnt(10)
    v_mfma_f32_16x16x32_bf16 v[100:103], v[72:75], v[44:47], v[100:103]
    ds_read_b64_tr_b16 v[72:73], v48 offset:22528
    ds_read_b64_tr_b16 v[74:75], v48 offset:22784
    s_waitcnt lgkmcnt(10)
    v_mfma_f32_16x16x32_bf16 v[100:103], v[52:55], v[44:47], v[100:103]
    ds_read_b64_tr_b16 v[52:53], v48 offset:24576
    ds_read_b64_tr_b16 v[54:55], v48 offset:24832
    s_waitcnt lgkmcnt(10)
    v_mfma_f32_16x16x32_bf16 v[100:103], v[56:59], v[44:47], v[100:103]
    ds_read_b64_tr_b16 v[56:57], v48 offset:26624
    ds_read_b64_tr_b16 v[58:59], v48 offset:26880
    s_waitcnt lgkmcnt(10)
    v_mfma_f32_16x16x32_bf16 v[100:103], v[60:63], v[44:47], v[100:103]
    ds_read_b64_tr_b16 v[60:61], v48 offset:28672
    ds_read_b64_tr_b16 v[62:63], v48 offset:28928
    s_waitcnt lgkmcnt(10)
    v_mfma_f32_16x16x32_bf16 v[100:103], v[64:67], v[44:47], v[100:103]
    ds_read_b64_tr_b16 v[64:65], v48 offset:30720
    ds_read_b64_tr_b16 v[66:67], v48 offset:30976
    s_waitcnt lgkmcnt(10)
    v_mfma_f32_16x16x32_bf16 v[100:103], v[68:71], v[44:47], v[100:103]
    s_waitcnt lgkmcnt(8)
    v_mfma_f32_16x16x32_bf16 v[100:103], v[72:75], v[44:47], v[100:103]
    s_waitcnt lgkmcnt(6)
    v_mfma_f32_16x16x32_bf16 v[100:103], v[52:55], v[44:47], v[100:103]
    s_waitcnt lgkmcnt(4)
    v_mfma_f32_16x16x32_bf16 v[100:103], v[56:59], v[44:47], v[100:103]
    s_waitcnt lgkmcnt(2)
    v_mfma_f32_16x16x32_bf16 v[100:103], v[60:63], v[44:47], v[100:103]
    s_waitcnt lgkmcnt(0)
    v_mfma_f32_16x16x32_bf16 v[100:103], v[64:67], v[44:47], v[100:103]
    v_lshrrev_b32 v5, 4, v1
    v_lshlrev_b32 v5, 4, v5
    s_lshl_b32 s46, s45, 6
    s_add_u32 s46, s46, 147968
    v_add_u32 v5, s46, v5
    s_nop 2
    ds_write_b128 v5, v[100:103]
    s_add_u32 s45, s45, 1
    s_cmp_eq_u32 s45, 3
    s_cbranch_scc1 A_CS
    s_waitcnt lgkmcnt(0)
    s_barrier
    s_waitcnt vmcnt(0)
    s_mov_b32 s58, 0x05040100
    s_mov_b32 s59, 0x07060302
    v_perm_b32 v40, v33, v32, s58
    v_perm_b32 v44, v33, v32, s59
    v_perm_b32 v41, v35, v34, s58
    v_perm_b32 v45, v35, v34, s59
    v_perm_b32 v42, v37, v36, s58
    v_perm_b32 v46, v37, v36, s59
    v_perm_b32 v43, v39, v38, s58
    v_perm_b32 v47, v39, v38, s59
    buffer_store_dwordx4 v[40:43], v3, s[36:39], s56 offen sc1
    buffer_store_dwordx4 v[44:47], v3, s[36:39], s57 offen sc1
    s_cmp_lg_u32 s3, 4
    s_cbranch_scc1 A_B4
    s_mov_b32 s24, s18
    s_mov_b32 s25, s19
    s_mov_b32 s26, 0x100
    s_mov_b32 s27, 0x00020000
    s_lshl_b32 s45, s68, 7
    s_add_u32 s45, s45, 139360
    v_mov_b32 v9, 0
    s_mov_b32 s69, 0
    s_mov_b64 exec, 1
A_PK:
    buffer_load_dword v8, v9, s[36:39], s45 offen sc1
    s_add_u32 s69, s69, 1
    s_waitcnt vmcnt(0)
    v_cmp_eq_u32 vcc, 1, v8
    s_nop 4
    s_cbranch_vccnz A_PK_D
    s_cmp_lt_u32 s69, 40000
    s_nop 4
    s_cbranch_scc1 A_PK
A_PK_D:
    s_mov_b64 exec, -1
    s_lshl_b32 s45, s40, 1
    s_add_u32 s46, s45, 0
    s_and_b32 s46, s46, 63
    s_lshl_b32 s46, s46, 11
    s_mov_b32 m0, 149504
    s_nop 0
    buffer_load_dwordx4 v3, s[36:39], s46 offen lds
    buffer_load_dwordx4 v3, s[36:39], s46 offen offset:1024 lds
    s_add_u32 s46, s45, 1
    s_and_b32 s46, s46, 63
    s_lshl_b32 s46, s46, 11
    s_mov_b32 m0, 151552
    s_nop 0
    buffer_load_dwordx4 v3, s[36:39], s46 offen lds
    buffer_load_dwordx4 v3, s[36:39], s46 offen offset:1024 lds
    s_add_u32 s46, s45, 2
    s_and_b32 s46, s46, 63
    s_lshl_b32 s46, s46, 11
    s_mov_b32 m0, 153600
    s_nop 0
    buffer_load_dwordx4 v3, s[36:39], s46 offen lds
    buffer_load_dwordx4 v3, s[36:39], s46 offen offset:1024 lds
    s_add_u32 s46, s45, 3
    s_and_b32 s46, s46, 63
    s_lshl_b32 s46, s46, 11
    s_mov_b32 m0, 155648
    s_nop 0
    buffer_load_dwordx4 v3, s[36:39], s46 offen lds
    buffer_load_dwordx4 v3, s[36:39], s46 offen offset:1024 lds
    s_add_u32 s46, s45, 4
    s_and_b32 s46, s46, 63
    s_lshl_b32 s46, s46, 11
    s_mov_b32 m0, 157696
    s_nop 0
    buffer_load_dwordx4 v3, s[36:39], s46 offen lds
    buffer_load_dwordx4 v3, s[36:39], s46 offen offset:1024 lds
    s_add_u32 s46, s45, 5
    s_and_b32 s46, s46, 63
    s_lshl_b32 s46, s46, 11
    s_mov_b32 m0, 159744
    s_nop 0
    buffer_load_dwordx4 v3, s[36:39], s46 offen lds
    buffer_load_dwordx4 v3, s[36:39], s46 offen offset:1024 lds
    s_add_u32 s46, s45, 6
    s_and_b32 s46, s46, 63
    s_lshl_b32 s46, s46, 11
    s_mov_b32 m0, 161792
    s_nop 0
    buffer_load_dwordx4 v3, s[36:39], s46 offen lds
    buffer_load_dwordx4 v3, s[36:39], s46 offen offset:1024 lds
    v_lshlrev_b32 v4, 2, v1
    s_mov_b32 s46, 135168
    buffer_load_dword v10, v4, s[36:39], s46 offen sc1
    buffer_load_dword v11, v4, s[36:39], s46 offen offset:256 sc1
    v_and_b32 v4, 7, v1
    v_lshlrev_b32 v4, 7, v4
    s_lshl_b32 s46, s40, 10
    s_add_u32 s46, s46, 139388
    buffer_load_dword v12, v4, s[36:39], s46 offen sc1
    s_getreg_b32 s46, hwreg(HW_REG_XCC_ID)
    s_and_b32 s46, s46, 15
    s_waitcnt vmcnt(0)
    v_cmp_eq_u32 vcc, s46, v12
    s_nop 0
    s_cmp_eq_u64 vcc, -1
    s_cselect_b32 s46, 1, 0
    v_max_f32 v10, v10, v11
    s_nop 1
    v_max_f32_dpp v10, v10, v10 row_ror:8 row_mask:0xf bank_mask:0xf
    s_nop 1
    v_max_f32_dpp v10, v10, v10 row_ror:4 row_mask:0xf bank_mask:0xf
    s_nop 1
    v_max_f32_dpp v10, v10, v10 row_ror:2 row_mask:0xf bank_mask:0xf
    s_nop 1
    v_max_f32_dpp v10, v10, v10 row_ror:1 row_mask:0xf bank_mask:0xf
    v_mov_b32 v13, v10
    s_nop 1
    v_permlane16_swap_b32 v10, v13
    v_max_f32 v10, v10, v13
    v_mov_b32 v13, v10
    s_nop 1
    v_permlane32_swap_b32 v10, v13
    v_max_f32 v10, v10, v13
    v_mov_b32 v11, s46
    v_mov_b32 v5, 148224
    ds_write_b64 v5, v[10:11]
    s_branch A_B4
A_KV:
    buffer_load_dword v32, v20, s[32:35], s48 offen
    buffer_load_dword v33, v20, s[32:35], s49 offen
    buffer_load_dword v34, v20, s[32:35], s50 offen
    buffer_load_dword v35, v20, s[32:35], s51 offen
    buffer_load_dword v36, v20, s[32:35], s52 offen
    buffer_load_dword v37, v20, s[32:35], s53 offen
    buffer_load_dword v38, v20, s[32:35], s54 offen
    buffer_load_dword v39, v20, s[32:35], s55 offen
    v_and_b32 v2, 15, v1
    v_lshrrev_b32 v28, 4, v1
    s_lshr_b32 s46, s41, 1
    s_lshl_b32 s47, s46, 14
    v_xor_b32 v4, v2, v28
    v_lshlrev_b32 v4, 4, v4
    v_lshl_add_u32 v4, v2, 10, v4
    v_add_u32 v40, s47, v4
    v_xor_b32 v41, 64, v40
    v_xor_b32 v42, 128, v40
    v_xor_b32 v43, 192, v40
    v_lshlrev_b32 v5, 8, v28
    v_bfe_u32 v6, v1, 2, 2
    v_lshl_add_u32 v5, v6, 5, v5
    v_and_b32 v6, 3, v1
    v_lshl_add_u32 v5, v6, 3, v5
    v_add_u32 v48, 131072, v5
    v_mov_b32 v44, 0x3f803f80
    v_mov_b32 v45, 0x3f803f80
    v_mov_b32 v46, 0x3f803f80
    v_mov_b32 v47, 0x3f803f80
    v_mov_b32 v100, 0
    v_mov_b32 v101, 0
    v_mov_b32 v102, 0
    v_mov_b32 v103, 0
    v_mov_b32 v104, 0
    v_mov_b32 v105, 0
    v_mov_b32 v106, 0
    v_mov_b32 v107, 0
    s_lshl_b32 s47, s40, 1
    s_lshr_b32 s48, s41, 2
    s_add_u32 s47, s47, s48
    s_lshl_b32 s47, s47, 11
    s_and_b32 s48, s46, 1
    s_and_b32 s49, s41, 1
    s_cmp_eq_u32 s49, 1
    s_cbranch_scc1 A_V
    s_lshl_b32 s50, s46, 7
    s_add_u32 s50, s50, 147456
    v_lshlrev_b32 v12, 3, v2
    v_add_u32 v12, s50, v12
    v_and_b32 v13, 1, v28
    v_lshlrev_b32 v13, 9, v13
    v_lshl_add_u32 v13, v2, 4, v13
    v_lshrrev_b32 v6, 1, v28
    v_lshl_add_u32 v13, v6, 3, v13
    s_lshl_b32 s48, s48, 8
    s_add_u32 s47, s47, s48
    s_lshl_b32 s50, s40, 2
    s_add_u32 s50, s50, s46
    s_lshl_b32 s50, s50, 2
    s_add_u32 s50, s50, 135168
    s_waitcnt vmcnt(16)
    s_barrier
    ds_read_b64_tr_b16 v[52:53], v48 offset:0
    ds_read_b64_tr_b16 v[54:55], v48 offset:128
    ds_read_b128 v[56:59], v40 offset:0
    ds_read_b64_tr_b16 v[60:61], v48 offset:1024
    ds_read_b64_tr_b16 v[62:63], v48 offset:1152
    ds_read_b128 v[64:67], v41 offset:0
    ds_read_b64_tr_b16 v[68:69], v48 offset:2048
    ds_read_b64_tr_b16 v[70:71], v48 offset:2176
    ds_read_b128 v[72:75], v42 offset:0
    ds_read_b64_tr_b16 v[76:77], v48 offset:3072
    ds_read_b64_tr_b16 v[78:79], v48 offset:3200
    ds_read_b128 v[80:83], v43 offset:0
    s_waitcnt lgkmcnt(9)
    v_mfma_f32_16x16x32_bf16 v[100:103], v[52:55], v[56:59], v[100:103]
    v_mfma_f32_16x16x32_bf16 v[104:107], v[52:55], v[44:47], v[104:107]
    ds_read_b64_tr_b16 v[52:53], v48 offset:4096
    ds_read_b64_tr_b16 v[54:55], v48 offset:4224
    ds_read_b128 v[56:59], v40 offset:256
    s_waitcnt lgkmcnt(9)
    v_mfma_f32_16x16x32_bf16 v[100:103], v[60:63], v[64:67], v[100:103]
    v_mfma_f32_16x16x32_bf16 v[104:107], v[60:63], v[44:47], v[104:107]
    ds_read_b64_tr_b16 v[60:61], v48 offset:5120
    ds_read_b64_tr_b16 v[62:63], v48 offset:5248
    ds_read_b128 v[64:67], v41 offset:256
    s_waitcnt lgkmcnt(9)
    v_mfma_f32_16x16x32_bf16 v[100:103], v[68:71], v[72:75], v[100:103]
    v_mfma_f32_16x16x32_bf16 v[104:107], v[68:71], v[44:47], v[104:107]
    ds_read_b64_tr_b16 v[68:69], v48 offset:6144
    ds_read_b64_tr_b16 v[70:71], v48 offset:6272
    ds_read_b128 v[72:75], v42 offset:256
    s_waitcnt lgkmcnt(9)
    v_mfma_f32_16x16x32_bf16 v[100:103], v[76:79], v[80:83], v[100:103]
    v_mfma_f32_16x16x32_bf16 v[104:107], v[76:79], v[44:47], v[104:107]
    ds_read_b64_tr_b16 v[76:77], v48 offset:7168
    ds_read_b64_tr_b16 v[78:79], v48 offset:7296
    ds_read_b128 v[80:83], v43 offset:256
    s_waitcnt lgkmcnt(9)
    v_mfma_f32_16x16x32_bf16 v[100:103], v[52:55], v[56:59], v[100:103]
    v_mfma_f32_16x16x32_bf16 v[104:107], v[52:55], v[44:47], v[104:107]
    ds_read_b64_tr_b16 v[52:53], v48 offset:8192
    ds_read_b64_tr_b16 v[54:55], v48 offset:8320
    ds_read_b128 v[56:59], v40 offset:512
    s_waitcnt lgkmcnt(9)
    v_mfma_f32_16x16x32_bf16 v[100:103], v[60:63], v[64:67], v[100:103]
    v_mfma_f32_16x16x32_bf16 v[104:107], v[60:63], v[44:47], v[104:107]
    ds_read_b64_tr_b16 v[60:61], v48 offset:9216
    ds_read_b64_tr_b16 v[62:63], v48 offset:9344
    ds_read_b128 v[64:67], v41 offset:512
    s_waitcnt lgkmcnt(9)
    v_mfma_f32_16x16x32_bf16 v[100:103], v[68:71], v[72:75], v[100:103]
    v_mfma_f32_16x16x32_bf16 v[104:107], v[68:71], v[44:47], v[104:107]
    ds_read_b64_tr_b16 v[68:69], v48 offset:10240
    ds_read_b64_tr_b16 v[70:71], v48 offset:10368
    ds_read_b128 v[72:75], v42 offset:512
    s_waitcnt lgkmcnt(9)
    v_mfma_f32_16x16x32_bf16 v[100:103], v[76:79], v[80:83], v[100:103]
    v_mfma_f32_16x16x32_bf16 v[104:107], v[76:79], v[44:47], v[104:107]
    ds_read_b64_tr_b16 v[76:77], v48 offset:11264
    ds_read_b64_tr_b16 v[78:79], v48 offset:11392
    ds_read_b128 v[80:83], v43 offset:512
    s_waitcnt lgkmcnt(9)
    v_mfma_f32_16x16x32_bf16 v[100:103], v[52:55], v[56:59], v[100:103]
    v_mfma_f32_16x16x32_bf16 v[104:107], v[52:55], v[44:47], v[104:107]
    ds_read_b64_tr_b16 v[52:53], v48 offset:12288
    ds_read_b64_tr_b16 v[54:55], v48 offset:12416
    ds_read_b128 v[56:59], v40 offset:768
    s_waitcnt lgkmcnt(9)
    v_mfma_f32_16x16x32_bf16 v[100:103], v[60:63], v[64:67], v[100:103]
    v_mfma_f32_16x16x32_bf16 v[104:107], v[60:63], v[44:47], v[104:107]
    ds_read_b64_tr_b16 v[60:61], v48 offset:13312
    ds_read_b64_tr_b16 v[62:63], v48 offset:13440
    ds_read_b128 v[64:67], v41 offset:768
    s_waitcnt lgkmcnt(9)
    v_mfma_f32_16x16x32_bf16 v[100:103], v[68:71], v[72:75], v[100:103]
    v_mfma_f32_16x16x32_bf16 v[104:107], v[68:71], v[44:47], v[104:107]
    ds_read_b64_tr_b16 v[68:69], v48 offset:14336
    ds_read_b64_tr_b16 v[70:71], v48 offset:14464
    ds_read_b128 v[72:75], v42 offset:768
    s_waitcnt lgkmcnt(9)
    v_mfma_f32_16x16x32_bf16 v[100:103], v[76:79], v[80:83], v[100:103]
    v_mfma_f32_16x16x32_bf16 v[104:107], v[76:79], v[44:47], v[104:107]
    ds_read_b64_tr_b16 v[76:77], v48 offset:15360
    ds_read_b64_tr_b16 v[78:79], v48 offset:15488
    ds_read_b128 v[80:83], v43 offset:768
    s_waitcnt lgkmcnt(9)
    v_mfma_f32_16x16x32_bf16 v[100:103], v[52:55], v[56:59], v[100:103]
    v_mfma_f32_16x16x32_bf16 v[104:107], v[52:55], v[44:47], v[104:107]
    s_waitcnt lgkmcnt(6)
    v_mfma_f32_16x16x32_bf16 v[100:103], v[60:63], v[64:67], v[100:103]
    v_mfma_f32_16x16x32_bf16 v[104:107], v[60:63], v[44:47], v[104:107]
    s_waitcnt lgkmcnt(3)
    v_mfma_f32_16x16x32_bf16 v[100:103], v[68:71], v[72:75], v[100:103]
    v_mfma_f32_16x16x32_bf16 v[104:107], v[68:71], v[44:47], v[104:107]
    s_waitcnt lgkmcnt(0)
    v_mfma_f32_16x16x32_bf16 v[100:103], v[76:79], v[80:83], v[100:103]
    v_mfma_f32_16x16x32_bf16 v[104:107], v[76:79], v[44:47], v[104:107]
    s_barrier
    ds_read_b64 v[52:53], v12
    s_waitcnt lgkmcnt(0)
    s_nop 4
    v_mul_f32 v104, v53, v104
    v_mul_f32 v105, v53, v105
    v_mul_f32 v106, v53, v106
    v_mul_f32 v107, v53, v107
    v_fma_f32 v100, v52, v100, v104
    v_fma_f32 v101, v52, v101, v105
    v_fma_f32 v102, v52, v102, v106
    v_fma_f32 v103, v52, v103, v107
    v_cvt_pk_bf16_f32 v80, v100, v101
    v_cvt_pk_bf16_f32 v81, v102, v103
    buffer_store_dwordx2 v[80:81], v13, s[36:39], s47 offen sc1
    v_mul_f32 v54, v100, v100
    v_fmac_f32 v54, v101, v101
    v_fmac_f32 v54, v102, v102
    v_fmac_f32 v54, v103, v103
    v_mov_b32 v56, v54
    s_nop 1
    v_permlane16_swap_b32 v54, v56
    v_add_f32 v54, v54, v56
    v_mov_b32 v56, v54
    s_nop 1
    v_permlane32_swap_b32 v54, v56
    v_add_f32 v54, v54, v56
    s_nop 1
    v_max_f32_dpp v54, v54, v54 row_ror:8 row_mask:0xf bank_mask:0xf
    s_nop 1
    v_max_f32_dpp v54, v54, v54 row_ror:4 row_mask:0xf bank_mask:0xf
    s_nop 1
    v_max_f32_dpp v54, v54, v54 row_ror:2 row_mask:0xf bank_mask:0xf
    s_nop 1
    v_max_f32_dpp v54, v54, v54 row_ror:1 row_mask:0xf bank_mask:0xf
    v_mov_b32 v56, v54
    s_nop 1
    v_permlane16_swap_b32 v54, v56
    v_max_f32 v54, v54, v56
    v_mov_b32 v56, v54
    s_nop 1
    v_permlane32_swap_b32 v54, v56
    v_max_f32 v54, v54, v56
    v_mov_b32 v5, 0
    s_mov_b64 exec, 1
    buffer_store_dword v54, v5, s[36:39], s50 offen sc1
    s_mov_b64 exec, -1
    s_branch A_KVF
A_V:
    s_lshl_b32 s50, s46, 7
    s_add_u32 s50, s50, 147456
    v_lshlrev_b32 v12, 5, v28
    v_add_u32 v12, s50, v12
    v_and_b32 v13, 1, v28
    v_lshlrev_b32 v13, 8, v13
    v_lshl_add_u32 v13, v2, 4, v13
    v_lshrrev_b32 v6, 1, v28
    v_lshl_add_u32 v13, v6, 3, v13
    s_lshl_b32 s48, s48, 9
    s_add_u32 s47, s47, s48
    s_waitcnt vmcnt(16)
    s_barrier
    ds_read_b64_tr_b16 v[52:53], v48 offset:0
    ds_read_b64_tr_b16 v[54:55], v48 offset:128
    ds_read_b128 v[56:59], v40 offset:0
    ds_read_b64_tr_b16 v[60:61], v48 offset:1024
    ds_read_b64_tr_b16 v[62:63], v48 offset:1152
    ds_read_b128 v[64:67], v41 offset:0
    ds_read_b64_tr_b16 v[68:69], v48 offset:2048
    ds_read_b64_tr_b16 v[70:71], v48 offset:2176
    ds_read_b128 v[72:75], v42 offset:0
    ds_read_b64_tr_b16 v[76:77], v48 offset:3072
    ds_read_b64_tr_b16 v[78:79], v48 offset:3200
    ds_read_b128 v[80:83], v43 offset:0
    s_waitcnt lgkmcnt(9)
    v_mfma_f32_16x16x32_bf16 v[100:103], v[56:59], v[52:55], v[100:103]
    v_mfma_f32_16x16x32_bf16 v[104:107], v[44:47], v[52:55], v[104:107]
    ds_read_b64_tr_b16 v[52:53], v48 offset:4096
    ds_read_b64_tr_b16 v[54:55], v48 offset:4224
    ds_read_b128 v[56:59], v40 offset:256
    s_waitcnt lgkmcnt(9)
    v_mfma_f32_16x16x32_bf16 v[100:103], v[64:67], v[60:63], v[100:103]
    v_mfma_f32_16x16x32_bf16 v[104:107], v[44:47], v[60:63], v[104:107]
    ds_read_b64_tr_b16 v[60:61], v48 offset:5120
    ds_read_b64_tr_b16 v[62:63], v48 offset:5248
    ds_read_b128 v[64:67], v41 offset:256
    s_waitcnt lgkmcnt(9)
    v_mfma_f32_16x16x32_bf16 v[100:103], v[72:75], v[68:71], v[100:103]
    v_mfma_f32_16x16x32_bf16 v[104:107], v[44:47], v[68:71], v[104:107]
    ds_read_b64_tr_b16 v[68:69], v48 offset:6144
    ds_read_b64_tr_b16 v[70:71], v48 offset:6272
    ds_read_b128 v[72:75], v42 offset:256
    s_waitcnt lgkmcnt(9)
    v_mfma_f32_16x16x32_bf16 v[100:103], v[80:83], v[76:79], v[100:103]
    v_mfma_f32_16x16x32_bf16 v[104:107], v[44:47], v[76:79], v[104:107]
    ds_read_b64_tr_b16 v[76:77], v48 offset:7168
    ds_read_b64_tr_b16 v[78:79], v48 offset:7296
    ds_read_b128 v[80:83], v43 offset:256
    s_waitcnt lgkmcnt(9)
    v_mfma_f32_16x16x32_bf16 v[100:103], v[56:59], v[52:55], v[100:103]
    v_mfma_f32_16x16x32_bf16 v[104:107], v[44:47], v[52:55], v[104:107]
    ds_read_b64_tr_b16 v[52:53], v48 offset:8192
    ds_read_b64_tr_b16 v[54:55], v48 offset:8320
    ds_read_b128 v[56:59], v40 offset:512
    s_waitcnt lgkmcnt(9)
    v_mfma_f32_16x16x32_bf16 v[100:103], v[64:67], v[60:63], v[100:103]
    v_mfma_f32_16x16x32_bf16 v[104:107], v[44:47], v[60:63], v[104:107]
    ds_read_b64_tr_b16 v[60:61], v48 offset:9216
    ds_read_b64_tr_b16 v[62:63], v48 offset:9344
    ds_read_b128 v[64:67], v41 offset:512
    s_waitcnt lgkmcnt(9)
    v_mfma_f32_16x16x32_bf16 v[100:103], v[72:75], v[68:71], v[100:103]
    v_mfma_f32_16x16x32_bf16 v[104:107], v[44:47], v[68:71], v[104:107]
    ds_read_b64_tr_b16 v[68:69], v48 offset:10240
    ds_read_b64_tr_b16 v[70:71], v48 offset:10368
    ds_read_b128 v[72:75], v42 offset:512
    s_waitcnt lgkmcnt(9)
    v_mfma_f32_16x16x32_bf16 v[100:103], v[80:83], v[76:79], v[100:103]
    v_mfma_f32_16x16x32_bf16 v[104:107], v[44:47], v[76:79], v[104:107]
    ds_read_b64_tr_b16 v[76:77], v48 offset:11264
    ds_read_b64_tr_b16 v[78:79], v48 offset:11392
    ds_read_b128 v[80:83], v43 offset:512
    s_waitcnt lgkmcnt(9)
    v_mfma_f32_16x16x32_bf16 v[100:103], v[56:59], v[52:55], v[100:103]
    v_mfma_f32_16x16x32_bf16 v[104:107], v[44:47], v[52:55], v[104:107]
    ds_read_b64_tr_b16 v[52:53], v48 offset:12288
    ds_read_b64_tr_b16 v[54:55], v48 offset:12416
    ds_read_b128 v[56:59], v40 offset:768
    s_waitcnt lgkmcnt(9)
    v_mfma_f32_16x16x32_bf16 v[100:103], v[64:67], v[60:63], v[100:103]
    v_mfma_f32_16x16x32_bf16 v[104:107], v[44:47], v[60:63], v[104:107]
    ds_read_b64_tr_b16 v[60:61], v48 offset:13312
    ds_read_b64_tr_b16 v[62:63], v48 offset:13440
    ds_read_b128 v[64:67], v41 offset:768
    s_waitcnt lgkmcnt(9)
    v_mfma_f32_16x16x32_bf16 v[100:103], v[72:75], v[68:71], v[100:103]
    v_mfma_f32_16x16x32_bf16 v[104:107], v[44:47], v[68:71], v[104:107]
    ds_read_b64_tr_b16 v[68:69], v48 offset:14336
    ds_read_b64_tr_b16 v[70:71], v48 offset:14464
    ds_read_b128 v[72:75], v42 offset:768
    s_waitcnt lgkmcnt(9)
    v_mfma_f32_16x16x32_bf16 v[100:103], v[80:83], v[76:79], v[100:103]
    v_mfma_f32_16x16x32_bf16 v[104:107], v[44:47], v[76:79], v[104:107]
    ds_read_b64_tr_b16 v[76:77], v48 offset:15360
    ds_read_b64_tr_b16 v[78:79], v48 offset:15488
    ds_read_b128 v[80:83], v43 offset:768
    s_waitcnt lgkmcnt(9)
    v_mfma_f32_16x16x32_bf16 v[100:103], v[56:59], v[52:55], v[100:103]
    v_mfma_f32_16x16x32_bf16 v[104:107], v[44:47], v[52:55], v[104:107]
    s_waitcnt lgkmcnt(6)
    v_mfma_f32_16x16x32_bf16 v[100:103], v[64:67], v[60:63], v[100:103]
    v_mfma_f32_16x16x32_bf16 v[104:107], v[44:47], v[60:63], v[104:107]
    s_waitcnt lgkmcnt(3)
    v_mfma_f32_16x16x32_bf16 v[100:103], v[72:75], v[68:71], v[100:103]
    v_mfma_f32_16x16x32_bf16 v[104:107], v[44:47], v[68:71], v[104:107]
    s_waitcnt lgkmcnt(0)
    v_mfma_f32_16x16x32_bf16 v[100:103], v[80:83], v[76:79], v[100:103]
    v_mfma_f32_16x16x32_bf16 v[104:107], v[44:47], v[76:79], v[104:107]
    s_barrier
    ds_read_b128 v[52:55], v12
    ds_read_b128 v[56:59], v12 offset:16
    s_waitcnt lgkmcnt(0)
    s_nop 3
    v_mul_f32 v104, v53, v104
    v_mul_f32 v105, v55, v105
    v_mul_f32 v106, v57, v106
    v_mul_f32 v107, v59, v107
    v_fma_f32 v100, v52, v100, v104
    v_fma_f32 v101, v54, v101, v105
    v_fma_f32 v102, v56, v102, v106
    v_fma_f32 v103, v58, v103, v107
    v_cvt_pk_bf16_f32 v80, v100, v101
    v_cvt_pk_bf16_f32 v81, v102, v103
    buffer_store_dwordx2 v[80:81], v13, s[36:39], s47 offen offset:1024 sc1
A_KVF:
    v_and_b32 v2, 31, v1
    v_lshrrev_b32 v28, 5, v1
    s_lshr_b32 s45, s3, 2
    s_lshl_b32 s45, s45, 2
    s_lshl_b32 s61, s41, 3
    s_add_u32 s45, s45, s61
    v_add_u32 v4, s45, v28
    v_and_b32 v5, 15, v2
    v_xor_b32 v4, v4, v5
    v_lshlrev_b32 v4, 4, v4
    v_lshl_add_u32 v4, v2, 10, v4
    s_bfe_u32 s61, s3, 0x10001
    s_lshl_b32 s61, s61, 15
    v_add_u32 v4, s61, v4
    v_xor_b32 v5, 32, v4
    ds_read_b128 v[16:19], v4
    ds_read_b128 v[20:23], v5
    s_waitcnt vmcnt(0)
    s_mov_b32 s24, s18
    s_mov_b32 s25, s19
    s_mov_b32 s26, 0x100
    s_mov_b32 s27, 0x00020000
    s_and_b32 s46, s68, 3
    s_lshl_b32 s46, s46, 6
    v_mov_b32 v8, 0
    v_mov_b32 v9, 1
    s_mov_b64 exec, 1
    buffer_atomic_add v9, v8, s[24:27], s46 offen sc0 sc1
    s_mov_b64 exec, -1
    v_lshrrev_b32 v2, 3, v1
    v_and_b32 v14, 7, v1
    v_and_b32 v4, 1, v2
    v_lshlrev_b32 v5, 10, v2
    v_lshl_add_u32 v5, v14, 4, v5
    s_lshl_b32 s45, s60, 13
    v_add_u32 v5, s45, v5
    v_lshlrev_b32 v4, 7, v4
    v_add_u32 v6, v5, v4
    v_xor_b32 v4, 128, v4
    v_add_u32 v7, v5, v4
    ds_read_b128 v[52:55], v6 offset:0
    ds_read_b128 v[56:59], v7 offset:0
    ds_read_b128 v[60:63], v6 offset:256
    ds_read_b128 v[64:67], v7 offset:256
    ds_read_b128 v[68:71], v6 offset:512
    ds_read_b128 v[72:75], v7 offset:512
    ds_read_b128 v[76:79], v6 offset:768
    ds_read_b128 v[80:83], v7 offset:768
    v_mov_b32 v8, 0x3f803f80
    v_mov_b32 v84, 0
    v_mov_b32 v85, 0
    v_mov_b32 v86, 0
    v_mov_b32 v87, 0
    v_mov_b32 v88, 0
    v_mov_b32 v89, 0
    v_mov_b32 v90, 0
    v_mov_b32 v91, 0
    s_waitcnt lgkmcnt(7)
    v_dot2c_f32_bf16 v84, v52, v8
    v_dot2c_f32_bf16 v88, v52, v52
    v_dot2c_f32_bf16 v85, v53, v8
    v_dot2c_f32_bf16 v89, v53, v53
    v_dot2c_f32_bf16 v86, v54, v8
    v_dot2c_f32_bf16 v90, v54, v54
    v_dot2c_f32_bf16 v87, v55, v8
    v_dot2c_f32_bf16 v91, v55, v55
    s_waitcnt lgkmcnt(6)
    v_dot2c_f32_bf16 v84, v56, v8
    v_dot2c_f32_bf16 v88, v56, v56
    v_dot2c_f32_bf16 v85, v57, v8
    v_dot2c_f32_bf16 v89, v57, v57
    v_dot2c_f32_bf16 v86, v58, v8
    v_dot2c_f32_bf16 v90, v58, v58
    v_dot2c_f32_bf16 v87, v59, v8
    v_dot2c_f32_bf16 v91, v59, v59
    s_waitcnt lgkmcnt(5)
    v_dot2c_f32_bf16 v84, v60, v8
    v_dot2c_f32_bf16 v88, v60, v60
    v_dot2c_f32_bf16 v85, v61, v8
    v_dot2c_f32_bf16 v89, v61, v61
    v_dot2c_f32_bf16 v86, v62, v8
    v_dot2c_f32_bf16 v90, v62, v62
    v_dot2c_f32_bf16 v87, v63, v8
    v_dot2c_f32_bf16 v91, v63, v63
    s_waitcnt lgkmcnt(4)
    v_dot2c_f32_bf16 v84, v64, v8
    v_dot2c_f32_bf16 v88, v64, v64
    v_dot2c_f32_bf16 v85, v65, v8
    v_dot2c_f32_bf16 v89, v65, v65
    v_dot2c_f32_bf16 v86, v66, v8
    v_dot2c_f32_bf16 v90, v66, v66
    v_dot2c_f32_bf16 v87, v67, v8
    v_dot2c_f32_bf16 v91, v67, v67
    s_waitcnt lgkmcnt(3)
    v_dot2c_f32_bf16 v84, v68, v8
    v_dot2c_f32_bf16 v88, v68, v68
    v_dot2c_f32_bf16 v85, v69, v8
    v_dot2c_f32_bf16 v89, v69, v69
    v_dot2c_f32_bf16 v86, v70, v8
    v_dot2c_f32_bf16 v90, v70, v70
    v_dot2c_f32_bf16 v87, v71, v8
    v_dot2c_f32_bf16 v91, v71, v71
    s_waitcnt lgkmcnt(2)
    v_dot2c_f32_bf16 v84, v72, v8
    v_dot2c_f32_bf16 v88, v72, v72
    v_dot2c_f32_bf16 v85, v73, v8
    v_dot2c_f32_bf16 v89, v73, v73
    v_dot2c_f32_bf16 v86, v74, v8
    v_dot2c_f32_bf16 v90, v74, v74
    v_dot2c_f32_bf16 v87, v75, v8
    v_dot2c_f32_bf16 v91, v75, v75
    s_waitcnt lgkmcnt(1)
    v_dot2c_f32_bf16 v84, v76, v8
    v_dot2c_f32_bf16 v88, v76, v76
    v_dot2c_f32_bf16 v85, v77, v8
    v_dot2c_f32_bf16 v89, v77, v77
    v_dot2c_f32_bf16 v86, v78, v8
    v_dot2c_f32_bf16 v90, v78, v78
    v_dot2c_f32_bf16 v87, v79, v8
    v_dot2c_f32_bf16 v91, v79, v79
    s_waitcnt lgkmcnt(0)
    v_dot2c_f32_bf16 v84, v80, v8
    v_dot2c_f32_bf16 v88, v80, v80
    v_dot2c_f32_bf16 v85, v81, v8
    v_dot2c_f32_bf16 v89, v81, v81
    v_dot2c_f32_bf16 v86, v82, v8
    v_dot2c_f32_bf16 v90, v82, v82
    v_dot2c_f32_bf16 v87, v83, v8
    v_dot2c_f32_bf16 v91, v83, v83
    v_add_f32 v84, v84, v85
    s_nop 0
    v_add_f32 v86, v86, v87
    v_add_f32 v88, v88, v89
    v_add_f32 v90, v90, v91
    v_add_f32 v84, v84, v86
    v_add_f32 v88, v88, v90
    s_nop 0
    v_add_f32_dpp v84, v84, v84 quad_perm:[1,0,3,2] row_mask:0xf bank_mask:0xf
    v_add_f32_dpp v88, v88, v88 quad_perm:[1,0,3,2] row_mask:0xf bank_mask:0xf
    s_nop 0
    v_add_f32_dpp v84, v84, v84 quad_perm:[2,3,0,1] row_mask:0xf bank_mask:0xf
    v_add_f32_dpp v88, v88, v88 quad_perm:[2,3,0,1] row_mask:0xf bank_mask:0xf
    s_nop 0
    v_add_f32_dpp v84, v84, v84 row_half_mirror row_mask:0xf bank_mask:0xf
    v_add_f32_dpp v88, v88, v88 row_half_mirror row_mask:0xf bank_mask:0xf
    v_mul_f32 v84, 0x3b000000, v84
    v_mul_f32 v88, 0x3b000000, v88
    v_fma_f32 v88, -v84, v84, v88
    v_max_f32 v88, 0, v88
    v_add_f32 v88, 0x3727c5ac, v88
    v_rsq_f32 v88, v88
    s_nop 0
    v_mul_f32 v89, v84, v88
    v_sub_f32 v89, 0, v89
    v_lshlrev_b32 v5, 3, v2
    s_lshl_b32 s45, s60, 6
    s_add_u32 s45, s45, 147456
    v_add_u32 v5, s45, v5
    ds_write_b64 v5, v[88:89]
    s_waitcnt lgkmcnt(0)
    s_barrier
    v_mov_b32 v8, 0
    v_mov_b32 v11, 1
    s_waitcnt vmcnt(0)
    v_readfirstlane_b32 s46, v9
    s_nop 0
    s_cmp_lg_u32 s46, 63
    s_cbranch_scc1 A_KVG
    v_mov_b32 v9, 1
    s_mov_b64 exec, 1
    buffer_atomic_add v9, v8, s[24:27], 0 offen offset:16 sc0 sc1
    s_waitcnt vmcnt(0)
    v_readfirstlane_b32 s46, v9
    s_nop 0
    s_add_u32 s46, s46, 1
    s_mov_b32 s69, 0
A_KL:
    s_cmp_eq_u32 s46, 4
    s_cbranch_scc1 A_KB
    v_mov_b32 v9, 0
    buffer_atomic_add v9, v8, s[24:27], 0 offen offset:16 sc0 sc1
    s_add_u32 s69, s69, 1
    s_waitcnt vmcnt(0)
    v_readfirstlane_b32 s46, v9
    s_cmp_lt_u32 s69, 40000
    s_cbranch_scc1 A_KL
A_KB:
    s_mov_b64 exec, -1
    v_lshlrev_b32 v10, 7, v1
    s_and_b32 s46, s68, 3
    s_lshl_b32 s46, s46, 13
    s_add_u32 s46, s46, 139360
    buffer_store_dword v11, v10, s[36:39], s46 offen sc1
A_KVG:
    s_mov_b32 s58, 0x05040100
    s_mov_b32 s59, 0x07060302
    v_perm_b32 v40, v33, v32, s58
    v_perm_b32 v44, v33, v32, s59
    v_perm_b32 v41, v35, v34, s58
    v_perm_b32 v45, v35, v34, s59
    v_perm_b32 v42, v37, v36, s58
    v_perm_b32 v46, v37, v36, s59
    v_perm_b32 v43, v39, v38, s58
    v_perm_b32 v47, v39, v38, s59
    buffer_store_dwordx4 v[40:43], v3, s[36:39], s56 offen sc1
    buffer_store_dwordx4 v[44:47], v3, s[36:39], s57 offen sc1
    s_barrier
A_B4:
    s_mov_b32 s24, s18
    s_mov_b32 s25, s19
    s_mov_b32 s26, 0x100
    s_mov_b32 s27, 0x00020000
    s_waitcnt vmcnt(0) lgkmcnt(0)
    s_barrier
    s_cmp_lg_u32 s3, 0
    s_cbranch_scc1 SKF_1
    s_and_b32 s46, s68, 3
    s_lshl_b32 s46, s46, 6
    v_mov_b32 v8, 0
    v_mov_b32 v9, 1
    s_mov_b64 exec, 1
    buffer_atomic_add v9, v8, s[24:27], s46 offen offset:32 sc1
    s_mov_b64 exec, -1
SKF_1:
    v_add_u32 v4, 32768, v3
    v_add_u32 v5, 0x10000, v4
    v_and_b32 v6, 15, v1
    v_lshlrev_b32 v6, 4, v6
    v_lshrrev_b32 v7, 5, v1
    v_lshl_add_u32 v6, v7, 8, v6
    v_add_u32 v6, 33792, v6
    v_add_u32 v7, 0x10000, v6
    s_mov_b32 s54, 0x0000ffff
    s_mov_b32 s55, 0x0000ffff
    v_mov_b32 v8, 148224
    ds_read_b64 v[10:11], v8
    ds_read_b128 v[12:15], v8 offset:16
    s_cmp_lt_u32 s3, 4
    s_cbranch_scc1 SKQ_2
    s_sub_u32 s46, s3, 4
    s_lshl_b32 s46, s46, 10
    v_add_u32 v9, s46, v3
    ds_read_b128 v[24:27], v9 offset:0
SKQ_2:
    ds_read_b128 v[28:31], v5 offset:51200
    ds_read_b128 v[32:35], v5 offset:53248
    v_mov_b32 v36, 0x3f803f80
    v_mov_b32 v37, 0x3f803f80
    v_mov_b32 v38, 0x3f803f80
    v_mov_b32 v39, 0x3f803f80
    v_mov_b32 v40, 0x3f803f80
    v_mov_b32 v41, 0x3f803f80
    v_mov_b32 v42, 0x3f803f80
    v_mov_b32 v43, 0x3f803f80
    v_mov_b32 v44, 0x3f803f80
    v_mov_b32 v45, 0x3f803f80
    v_mov_b32 v46, 0x3f803f80
    v_mov_b32 v47, 0x3f803f80
    v_mov_b32 v48, 0x3f803f80
    v_mov_b32 v49, 0x3f803f80
    v_mov_b32 v50, 0x3f803f80
    v_mov_b32 v51, 0x3f803f80
    s_mov_b64 exec, s[54:55]
    ds_read_b128 v[36:39], v7 offset:51200
    ds_read_b128 v[40:43], v7 offset:51712
    s_mov_b64 exec, -1
    s_lshl_b32 s44, s40, 1
    s_add_u32 s44, s44, s3
    s_add_u32 s44, s44, 7
    s_lshl_b32 s45, s3, 11
    s_add_u32 s45, s45, 32768
    s_lshl_b32 s50, s41, 16
    s_and_b32 s46, s3, 1
    s_lshl_b32 s46, s46, 15
    s_add_u32 s50, s50, s46
    s_lshr_b32 s46, s3, 2
    s_lshl_b32 s46, s46, 14
    s_add_u32 s50, s50, s46
    s_add_u32 s50, s50, 3145728
    s_min_u32 s46, s3, 6
    s_mul_i32 s47, s41, 7
    s_add_u32 s53, s46, s47
    s_lshl_b32 s51, s53, 15
    s_add_u32 s51, s51, 4194304
    s_waitcnt lgkmcnt(0)
    v_max_f32 v12, v12, v13
    v_max_f32 v14, v14, v15
    v_max_f32 v12, v12, v14
    v_mul_f32 v12, v12, v10
    v_readfirstlane_b32 s62, v11
    v_mov_b32 v13, 0x4573c000
    v_cmp_le_f32 vcc, v12, v13
    s_nop 0
    s_cmp_eq_u64 vcc, -1
    s_cbranch_scc0 B_SLOW
    v_mfma_f32_32x32x16_bf16 v[52:67], v[28:31], v[24:27], 0
    s_nop 11
    v_exp_f32 v52, v52
    v_exp_f32 v53, v53
    s_waitcnt lgkmcnt(0)
    ds_read_b128 v[28:31], v5 offset:55296
    v_exp_f32 v54, v54
    v_exp_f32 v55, v55
    v_mfma_f32_32x32x16_bf16 v[68:83], v[32:35], v[24:27], 0
    s_mov_b64 exec, s[54:55]
    ds_read_b128 v[44:47], v7 offset:53248
    ds_read_b128 v[48:51], v7 offset:53760
    s_mov_b64 exec, -1
    v_exp_f32 v56, v56
    v_exp_f32 v57, v57
    v_exp_f32 v58, v58
    v_exp_f32 v59, v59
    v_cvt_pk_bf16_f32 v52, v52, v53
    v_cvt_pk_bf16_f32 v53, v54, v55
    v_cvt_pk_bf16_f32 v54, v56, v57
    v_cvt_pk_bf16_f32 v55, v58, v59
    v_exp_f32 v60, v60
    v_exp_f32 v61, v61
    v_mfma_f32_32x32x16_bf16 v[84:99], v[36:39], v[52:55], 0
    s_add_u32 s46, s44, 0
    s_and_b32 s46, s46, 63
    s_lshl_b32 s46, s46, 11
    s_add_u32 s47, s45, 0
    s_mov_b32 m0, s47
    s_nop 0
    buffer_load_dwordx4 v3, s[36:39], s46 offen lds
    buffer_load_dwordx4 v3, s[36:39], s46 offen offset:1024 lds
    v_exp_f32 v62, v62
    v_exp_f32 v63, v63
    v_exp_f32 v64, v64
    v_exp_f32 v65, v65
    v_exp_f32 v66, v66
    v_exp_f32 v67, v67
    v_cvt_pk_bf16_f32 v56, v60, v61
    v_cvt_pk_bf16_f32 v57, v62, v63
    v_cvt_pk_bf16_f32 v58, v64, v65
    v_cvt_pk_bf16_f32 v59, v66, v67
    v_exp_f32 v68, v68
    v_exp_f32 v69, v69
    v_mfma_f32_32x32x16_bf16 v[84:99], v[40:43], v[56:59], v[84:99]
    s_waitcnt lgkmcnt(0)
    ds_read_b128 v[32:35], v5 offset:57344
    v_exp_f32 v70, v70
    v_exp_f32 v71, v71
    v_mfma_f32_32x32x16_bf16 v[52:67], v[28:31], v[24:27], 0
    s_mov_b64 exec, s[54:55]
    ds_read_b128 v[36:39], v7 offset:55296
    ds_read_b128 v[40:43], v7 offset:55808
    s_mov_b64 exec, -1
    v_exp_f32 v72, v72
    v_exp_f32 v73, v73
    v_exp_f32 v74, v74
    v_exp_f32 v75, v75
    v_cvt_pk_bf16_f32 v68, v68, v69
    v_cvt_pk_bf16_f32 v69, v70, v71
    v_cvt_pk_bf16_f32 v70, v72, v73
    v_cvt_pk_bf16_f32 v71, v74, v75
    v_exp_f32 v76, v76
    v_exp_f32 v77, v77
    v_mfma_f32_32x32x16_bf16 v[84:99], v[44:47], v[68:71], v[84:99]
    s_add_u32 s46, s44, 8
    s_and_b32 s46, s46, 63
    s_lshl_b32 s46, s46, 11
    s_add_u32 s47, s45, 16384
    s_mov_b32 m0, s47
    s_nop 0
    buffer_load_dwordx4 v3, s[36:39], s46 offen lds
    buffer_load_dwordx4 v3, s[36:39], s46 offen offset:1024 lds
    v_exp_f32 v78, v78
    v_exp_f32 v79, v79
    v_exp_f32 v80, v80
    v_exp_f32 v81, v81
    v_exp_f32 v82, v82
    v_exp_f32 v83, v83
    v_cvt_pk_bf16_f32 v72, v76, v77
    v_cvt_pk_bf16_f32 v73, v78, v79
    v_cvt_pk_bf16_f32 v74, v80, v81
    v_cvt_pk_bf16_f32 v75, v82, v83
    v_exp_f32 v52, v52
    v_exp_f32 v53, v53
    v_mfma_f32_32x32x16_bf16 v[84:99], v[48:51], v[72:75], v[84:99]
    s_waitcnt lgkmcnt(0)
    ds_read_b128 v[28:31], v5 offset:59392
    v_exp_f32 v54, v54
    v_exp_f32 v55, v55
    v_mfma_f32_32x32x16_bf16 v[68:83], v[32:35], v[24:27], 0
    s_mov_b64 exec, s[54:55]
    ds_read_b128 v[44:47], v7 offset:57344
    ds_read_b128 v[48:51], v7 offset:57856
    s_mov_b64 exec, -1
    v_exp_f32 v56, v56
    v_exp_f32 v57, v57
    v_exp_f32 v58, v58
    v_exp_f32 v59, v59
    v_cvt_pk_bf16_f32 v52, v52, v53
    v_cvt_pk_bf16_f32 v53, v54, v55
    v_cvt_pk_bf16_f32 v54, v56, v57
    v_cvt_pk_bf16_f32 v55, v58, v59
    v_exp_f32 v60, v60
    v_exp_f32 v61, v61
    v_mfma_f32_32x32x16_bf16 v[84:99], v[36:39], v[52:55], v[84:99]
    s_add_u32 s46, s44, 16
    s_and_b32 s46, s46, 63
    s_lshl_b32 s46, s46, 11
    s_add_u32 s47, s45, 32768
    s_mov_b32 m0, s47
    s_nop 0
    buffer_load_dwordx4 v3, s[36:39], s46 offen lds
    buffer_load_dwordx4 v3, s[36:39], s46 offen offset:1024 lds
    v_exp_f32 v62, v62
    v_exp_f32 v63, v63
    v_exp_f32 v64, v64
    v_exp_f32 v65, v65
    v_exp_f32 v66, v66
    v_exp_f32 v67, v67
    v_cvt_pk_bf16_f32 v56, v60, v61
    v_cvt_pk_bf16_f32 v57, v62, v63
    v_cvt_pk_bf16_f32 v58, v64, v65
    v_cvt_pk_bf16_f32 v59, v66, v67
    v_exp_f32 v68, v68
    v_exp_f32 v69, v69
    v_mfma_f32_32x32x16_bf16 v[84:99], v[40:43], v[56:59], v[84:99]
    s_waitcnt lgkmcnt(0)
    ds_read_b128 v[32:35], v5 offset:61440
    v_exp_f32 v70, v70
    v_exp_f32 v71, v71
    v_mfma_f32_32x32x16_bf16 v[52:67], v[28:31], v[24:27], 0
    s_mov_b64 exec, s[54:55]
    ds_read_b128 v[36:39], v7 offset:59392
    ds_read_b128 v[40:43], v7 offset:59904
    s_mov_b64 exec, -1
    v_exp_f32 v72, v72
    v_exp_f32 v73, v73
    v_exp_f32 v74, v74
    v_exp_f32 v75, v75
    v_cvt_pk_bf16_f32 v68, v68, v69
    v_cvt_pk_bf16_f32 v69, v70, v71
    v_cvt_pk_bf16_f32 v70, v72, v73
    v_cvt_pk_bf16_f32 v71, v74, v75
    v_exp_f32 v76, v76
    v_exp_f32 v77, v77
    v_mfma_f32_32x32x16_bf16 v[84:99], v[44:47], v[68:71], v[84:99]
    s_add_u32 s46, s44, 24
    s_and_b32 s46, s46, 63
    s_lshl_b32 s46, s46, 11
    s_add_u32 s47, s45, 49152
    s_mov_b32 m0, s47
    s_nop 0
    buffer_load_dwordx4 v3, s[36:39], s46 offen lds
    buffer_load_dwordx4 v3, s[36:39], s46 offen offset:1024 lds
    v_exp_f32 v78, v78
    v_exp_f32 v79, v79
    v_exp_f32 v80, v80
    v_exp_f32 v81, v81
    v_exp_f32 v82, v82
    v_exp_f32 v83, v83
    v_cvt_pk_bf16_f32 v72, v76, v77
    v_cvt_pk_bf16_f32 v73, v78, v79
    v_cvt_pk_bf16_f32 v74, v80, v81
    v_cvt_pk_bf16_f32 v75, v82, v83
    v_exp_f32 v52, v52
    v_exp_f32 v53, v53
    v_mfma_f32_32x32x16_bf16 v[84:99], v[48:51], v[72:75], v[84:99]
    s_waitcnt lgkmcnt(0)
    ds_read_b128 v[28:31], v5 offset:63488
    v_exp_f32 v54, v54
    v_exp_f32 v55, v55
    v_mfma_f32_32x32x16_bf16 v[68:83], v[32:35], v[24:27], 0
    s_mov_b64 exec, s[54:55]
    ds_read_b128 v[44:47], v7 offset:61440
    ds_read_b128 v[48:51], v7 offset:61952
    s_mov_b64 exec, -1
    v_exp_f32 v56, v56
    v_exp_f32 v57, v57
    v_exp_f32 v58, v58
    v_exp_f32 v59, v59
    v_cvt_pk_bf16_f32 v52, v52, v53
    v_cvt_pk_bf16_f32 v53, v54, v55
    v_cvt_pk_bf16_f32 v54, v56, v57
    v_cvt_pk_bf16_f32 v55, v58, v59
    v_exp_f32 v60, v60
    v_exp_f32 v61, v61
    v_mfma_f32_32x32x16_bf16 v[84:99], v[36:39], v[52:55], v[84:99]
    s_add_u32 s46, s44, 32
    s_and_b32 s46, s46, 63
    s_lshl_b32 s46, s46, 11
    s_add_u32 s47, s45, 65536
    s_mov_b32 m0, s47
    s_nop 0
    buffer_load_dwordx4 v3, s[36:39], s46 offen lds
    buffer_load_dwordx4 v3, s[36:39], s46 offen offset:1024 lds
    v_exp_f32 v62, v62
    v_exp_f32 v63, v63
    v_exp_f32 v64, v64
    v_exp_f32 v65, v65
    v_exp_f32 v66, v66
    v_exp_f32 v67, v67
    v_cvt_pk_bf16_f32 v56, v60, v61
    v_cvt_pk_bf16_f32 v57, v62, v63
    v_cvt_pk_bf16_f32 v58, v64, v65
    v_cvt_pk_bf16_f32 v59, v66, v67
    v_exp_f32 v68, v68
    v_exp_f32 v69, v69
    v_mfma_f32_32x32x16_bf16 v[84:99], v[40:43], v[56:59], v[84:99]
    s_waitcnt vmcnt(8)
    s_barrier
    s_waitcnt lgkmcnt(0)
    ds_read_b128 v[32:35], v4 offset:0
    v_exp_f32 v70, v70
    v_exp_f32 v71, v71
    v_mfma_f32_32x32x16_bf16 v[52:67], v[28:31], v[24:27], 0
    s_mov_b64 exec, s[54:55]
    ds_read_b128 v[36:39], v7 offset:63488
    ds_read_b128 v[40:43], v7 offset:64000
    s_mov_b64 exec, -1
    v_exp_f32 v72, v72
    v_exp_f32 v73, v73
    v_exp_f32 v74, v74
    v_exp_f32 v75, v75
    v_cvt_pk_bf16_f32 v68, v68, v69
    v_cvt_pk_bf16_f32 v69, v70, v71
    v_cvt_pk_bf16_f32 v70, v72, v73
    v_cvt_pk_bf16_f32 v71, v74, v75
    v_exp_f32 v76, v76
    v_exp_f32 v77, v77
    v_mfma_f32_32x32x16_bf16 v[84:99], v[44:47], v[68:71], v[84:99]
    s_add_u32 s46, s44, 40
    s_and_b32 s46, s46, 63
    s_lshl_b32 s46, s46, 11
    s_add_u32 s47, s45, 81920
    s_mov_b32 m0, s47
    s_nop 0
    buffer_load_dwordx4 v3, s[36:39], s46 offen lds
    buffer_load_dwordx4 v3, s[36:39], s46 offen offset:1024 lds
    v_exp_f32 v78, v78
    v_exp_f32 v79, v79
    v_exp_f32 v80, v80
    v_exp_f32 v81, v81
    v_exp_f32 v82, v82
    v_exp_f32 v83, v83
    v_cvt_pk_bf16_f32 v72, v76, v77
    v_cvt_pk_bf16_f32 v73, v78, v79
    v_cvt_pk_bf16_f32 v74, v80, v81
    v_cvt_pk_bf16_f32 v75, v82, v83
    v_exp_f32 v52, v52
    v_exp_f32 v53, v53
    v_mfma_f32_32x32x16_bf16 v[84:99], v[48:51], v[72:75], v[84:99]
    s_waitcnt lgkmcnt(0)
    ds_read_b128 v[28:31], v4 offset:2048
    v_exp_f32 v54, v54
    v_exp_f32 v55, v55
    v_mfma_f32_32x32x16_bf16 v[68:83], v[32:35], v[24:27], 0
    s_mov_b64 exec, s[54:55]
    ds_read_b128 v[44:47], v6 offset:0
    ds_read_b128 v[48:51], v6 offset:512
    s_mov_b64 exec, -1
    v_exp_f32 v56, v56
    v_exp_f32 v57, v57
    v_exp_f32 v58, v58
    v_exp_f32 v59, v59
    v_cvt_pk_bf16_f32 v52, v52, v53
    v_cvt_pk_bf16_f32 v53, v54, v55
    v_cvt_pk_bf16_f32 v54, v56, v57
    v_cvt_pk_bf16_f32 v55, v58, v59
    v_exp_f32 v60, v60
    v_exp_f32 v61, v61
    v_mfma_f32_32x32x16_bf16 v[84:99], v[36:39], v[52:55], v[84:99]
    s_add_u32 s46, s44, 48
    s_and_b32 s46, s46, 63
    s_lshl_b32 s46, s46, 11
    s_add_u32 s47, s45, 98304
    s_mov_b32 m0, s47
    s_nop 0
    buffer_load_dwordx4 v3, s[36:39], s46 offen lds
    buffer_load_dwordx4 v3, s[36:39], s46 offen offset:1024 lds
    v_exp_f32 v62, v62
    v_exp_f32 v63, v63
    v_exp_f32 v64, v64
    v_exp_f32 v65, v65
    v_exp_f32 v66, v66
    v_exp_f32 v67, v67
    v_cvt_pk_bf16_f32 v56, v60, v61
    v_cvt_pk_bf16_f32 v57, v62, v63
    v_cvt_pk_bf16_f32 v58, v64, v65
    v_cvt_pk_bf16_f32 v59, v66, v67
    v_exp_f32 v68, v68
    v_exp_f32 v69, v69
    v_mfma_f32_32x32x16_bf16 v[84:99], v[40:43], v[56:59], v[84:99]
    s_waitcnt lgkmcnt(0)
    ds_read_b128 v[32:35], v4 offset:4096
    v_exp_f32 v70, v70
    v_exp_f32 v71, v71
    v_mfma_f32_32x32x16_bf16 v[52:67], v[28:31], v[24:27], 0
    s_mov_b64 exec, s[54:55]
    ds_read_b128 v[36:39], v6 offset:2048
    ds_read_b128 v[40:43], v6 offset:2560
    s_mov_b64 exec, -1
    v_exp_f32 v72, v72
    v_exp_f32 v73, v73
    v_exp_f32 v74, v74
    v_exp_f32 v75, v75
    v_cvt_pk_bf16_f32 v68, v68, v69
    v_cvt_pk_bf16_f32 v69, v70, v71
    v_cvt_pk_bf16_f32 v70, v72, v73
    v_cvt_pk_bf16_f32 v71, v74, v75
    v_exp_f32 v76, v76
    v_exp_f32 v77, v77
    v_mfma_f32_32x32x16_bf16 v[84:99], v[44:47], v[68:71], v[84:99]
    s_cmp_lg_u32 s3, 0
    s_cbranch_scc1 SKD_3
    s_add_u32 s46, s44, 56
    s_and_b32 s46, s46, 63
    s_lshl_b32 s46, s46, 11
    s_add_u32 s47, s45, 114688
    s_mov_b32 m0, s47
    s_nop 0
    buffer_load_dwordx4 v3, s[36:39], s46 offen lds
    buffer_load_dwordx4 v3, s[36:39], s46 offen offset:1024 lds
SKD_3:
    v_exp_f32 v78, v78
    v_exp_f32 v79, v79
    v_exp_f32 v80, v80
    v_exp_f32 v81, v81
    v_exp_f32 v82, v82
    v_exp_f32 v83, v83
    v_cvt_pk_bf16_f32 v72, v76, v77
    v_cvt_pk_bf16_f32 v73, v78, v79
    v_cvt_pk_bf16_f32 v74, v80, v81
    v_cvt_pk_bf16_f32 v75, v82, v83
    v_exp_f32 v52, v52
    v_exp_f32 v53, v53
    v_mfma_f32_32x32x16_bf16 v[84:99], v[48:51], v[72:75], v[84:99]
    s_waitcnt lgkmcnt(0)
    ds_read_b128 v[28:31], v4 offset:6144
    v_exp_f32 v54, v54
    v_exp_f32 v55, v55
    v_mfma_f32_32x32x16_bf16 v[68:83], v[32:35], v[24:27], 0
    s_mov_b64 exec, s[54:55]
    ds_read_b128 v[44:47], v6 offset:4096
    ds_read_b128 v[48:51], v6 offset:4608
    s_mov_b64 exec, -1
    v_exp_f32 v56, v56
    v_exp_f32 v57, v57
    v_exp_f32 v58, v58
    v_exp_f32 v59, v59
    v_cvt_pk_bf16_f32 v52, v52, v53
    v_cvt_pk_bf16_f32 v53, v54, v55
    v_cvt_pk_bf16_f32 v54, v56, v57
    v_cvt_pk_bf16_f32 v55, v58, v59
    v_exp_f32 v60, v60
    v_exp_f32 v61, v61
    v_mfma_f32_32x32x16_bf16 v[84:99], v[36:39], v[52:55], v[84:99]
    v_exp_f32 v62, v62
    v_exp_f32 v63, v63
    v_exp_f32 v64, v64
    v_exp_f32 v65, v65
    v_exp_f32 v66, v66
    v_exp_f32 v67, v67
    v_cvt_pk_bf16_f32 v56, v60, v61
    v_cvt_pk_bf16_f32 v57, v62, v63
    v_cvt_pk_bf16_f32 v58, v64, v65
    v_cvt_pk_bf16_f32 v59, v66, v67
    v_exp_f32 v68, v68
    v_exp_f32 v69, v69
    v_mfma_f32_32x32x16_bf16 v[84:99], v[40:43], v[56:59], v[84:99]
    s_waitcnt lgkmcnt(0)
    ds_read_b128 v[32:35], v4 offset:8192
    v_exp_f32 v70, v70
    v_exp_f32 v71, v71
    v_mfma_f32_32x32x16_bf16 v[52:67], v[28:31], v[24:27], 0
    s_mov_b64 exec, s[54:55]
    ds_read_b128 v[36:39], v6 offset:6144
    ds_read_b128 v[40:43], v6 offset:6656
    s_mov_b64 exec, -1
    v_exp_f32 v72, v72
    v_exp_f32 v73, v73
    v_exp_f32 v74, v74
    v_exp_f32 v75, v75
    v_cvt_pk_bf16_f32 v68, v68, v69
    v_cvt_pk_bf16_f32 v69, v70, v71
    v_cvt_pk_bf16_f32 v70, v72, v73
    v_cvt_pk_bf16_f32 v71, v74, v75
    v_exp_f32 v76, v76
    v_exp_f32 v77, v77
    v_mfma_f32_32x32x16_bf16 v[84:99], v[44:47], v[68:71], v[84:99]
    v_exp_f32 v78, v78
    v_exp_f32 v79, v79
    v_exp_f32 v80, v80
    v_exp_f32 v81, v81
    v_exp_f32 v82, v82
    v_exp_f32 v83, v83
    v_cvt_pk_bf16_f32 v72, v76, v77
    v_cvt_pk_bf16_f32 v73, v78, v79
    v_cvt_pk_bf16_f32 v74, v80, v81
    v_cvt_pk_bf16_f32 v75, v82, v83
    v_exp_f32 v52, v52
    v_exp_f32 v53, v53
    v_mfma_f32_32x32x16_bf16 v[84:99], v[48:51], v[72:75], v[84:99]
    s_waitcnt lgkmcnt(0)
    ds_read_b128 v[28:31], v4 offset:10240
    v_exp_f32 v54, v54
    v_exp_f32 v55, v55
    v_mfma_f32_32x32x16_bf16 v[68:83], v[32:35], v[24:27], 0
    s_mov_b64 exec, s[54:55]
    ds_read_b128 v[44:47], v6 offset:8192
    ds_read_b128 v[48:51], v6 offset:8704
    s_mov_b64 exec, -1
    v_exp_f32 v56, v56
    v_exp_f32 v57, v57
    v_exp_f32 v58, v58
    v_exp_f32 v59, v59
    v_cvt_pk_bf16_f32 v52, v52, v53
    v_cvt_pk_bf16_f32 v53, v54, v55
    v_cvt_pk_bf16_f32 v54, v56, v57
    v_cvt_pk_bf16_f32 v55, v58, v59
    v_exp_f32 v60, v60
    v_exp_f32 v61, v61
    v_mfma_f32_32x32x16_bf16 v[84:99], v[36:39], v[52:55], v[84:99]
    v_exp_f32 v62, v62
    v_exp_f32 v63, v63
    v_exp_f32 v64, v64
    v_exp_f32 v65, v65
    v_exp_f32 v66, v66
    v_exp_f32 v67, v67
    v_cvt_pk_bf16_f32 v56, v60, v61
    v_cvt_pk_bf16_f32 v57, v62, v63
    v_cvt_pk_bf16_f32 v58, v64, v65
    v_cvt_pk_bf16_f32 v59, v66, v67
    v_exp_f32 v68, v68
    v_exp_f32 v69, v69
    v_mfma_f32_32x32x16_bf16 v[84:99], v[40:43], v[56:59], v[84:99]
    s_waitcnt lgkmcnt(0)
    ds_read_b128 v[32:35], v4 offset:12288
    v_exp_f32 v70, v70
    v_exp_f32 v71, v71
    v_mfma_f32_32x32x16_bf16 v[52:67], v[28:31], v[24:27], 0
    s_mov_b64 exec, s[54:55]
    ds_read_b128 v[36:39], v6 offset:10240
    ds_read_b128 v[40:43], v6 offset:10752
    s_mov_b64 exec, -1
    v_exp_f32 v72, v72
    v_exp_f32 v73, v73
    v_exp_f32 v74, v74
    v_exp_f32 v75, v75
    v_cvt_pk_bf16_f32 v68, v68, v69
    v_cvt_pk_bf16_f32 v69, v70, v71
    v_cvt_pk_bf16_f32 v70, v72, v73
    v_cvt_pk_bf16_f32 v71, v74, v75
    v_exp_f32 v76, v76
    v_exp_f32 v77, v77
    v_mfma_f32_32x32x16_bf16 v[84:99], v[44:47], v[68:71], v[84:99]
    s_cmp_lg_u32 s3, 5
    s_cbranch_scc1 SKP_4
    v_and_b32 v9, 3, v1
    v_lshlrev_b32 v9, 6, v9
    buffer_load_dword v8, v9, s[24:27], 0 offen offset:32 sc1
SKP_4:
    v_exp_f32 v78, v78
    v_exp_f32 v79, v79
    v_exp_f32 v80, v80
    v_exp_f32 v81, v81
    v_exp_f32 v82, v82
    v_exp_f32 v83, v83
    v_cvt_pk_bf16_f32 v72, v76, v77
    v_cvt_pk_bf16_f32 v73, v78, v79
    v_cvt_pk_bf16_f32 v74, v80, v81
    v_cvt_pk_bf16_f32 v75, v82, v83
    v_exp_f32 v52, v52
    v_exp_f32 v53, v53
    v_mfma_f32_32x32x16_bf16 v[84:99], v[48:51], v[72:75], v[84:99]
    s_waitcnt lgkmcnt(0)
    ds_read_b128 v[28:31], v4 offset:14336
    v_exp_f32 v54, v54
    v_exp_f32 v55, v55
    v_mfma_f32_32x32x16_bf16 v[68:83], v[32:35], v[24:27], 0
    s_mov_b64 exec, s[54:55]
    ds_read_b128 v[44:47], v6 offset:12288
    ds_read_b128 v[48:51], v6 offset:12800
    s_mov_b64 exec, -1
    v_exp_f32 v56, v56
    v_exp_f32 v57, v57
    v_exp_f32 v58, v58
    v_exp_f32 v59, v59
    v_cvt_pk_bf16_f32 v52, v52, v53
    v_cvt_pk_bf16_f32 v53, v54, v55
    v_cvt_pk_bf16_f32 v54, v56, v57
    v_cvt_pk_bf16_f32 v55, v58, v59
    v_exp_f32 v60, v60
    v_exp_f32 v61, v61
    v_mfma_f32_32x32x16_bf16 v[84:99], v[36:39], v[52:55], v[84:99]
    v_exp_f32 v62, v62
    v_exp_f32 v63, v63
    v_exp_f32 v64, v64
    v_exp_f32 v65, v65
    v_exp_f32 v66, v66
    v_exp_f32 v67, v67
    v_cvt_pk_bf16_f32 v56, v60, v61
    v_cvt_pk_bf16_f32 v57, v62, v63
    v_cvt_pk_bf16_f32 v58, v64, v65
    v_cvt_pk_bf16_f32 v59, v66, v67
    v_exp_f32 v68, v68
    v_exp_f32 v69, v69
    v_mfma_f32_32x32x16_bf16 v[84:99], v[40:43], v[56:59], v[84:99]
    s_waitcnt vmcnt(0)
    s_cmp_lg_u32 s3, 5
    s_cbranch_scc1 SKP_5
    v_cmp_eq_u32 vcc, 64, v8
    s_nop 0
    s_cmp_eq_u64 vcc, -1
    s_cbranch_scc1 SKP_5
    s_mov_b32 s69, 0
    v_and_b32 v9, 3, v1
    v_lshlrev_b32 v9, 6, v9
    s_mov_b64 exec, 15
B_PW:
    buffer_load_dword v8, v9, s[24:27], 0 offen offset:32 sc1
    s_add_u32 s69, s69, 1
    s_waitcnt vmcnt(0)
    v_cmp_eq_u32 vcc, 64, v8
    s_nop 0
    s_cmp_eq_u64 vcc, 15
    s_cbranch_scc1 B_PW_D
    s_cmp_lt_u32 s69, 40000
    s_nop 0
    s_cbranch_scc1 B_PW
B_PW_D:
    s_mov_b64 exec, -1
SKP_5:
    s_barrier
    s_waitcnt lgkmcnt(0)
    ds_read_b128 v[32:35], v4 offset:16384
    v_exp_f32 v70, v70
    v_exp_f32 v71, v71
    v_mfma_f32_32x32x16_bf16 v[52:67], v[28:31], v[24:27], 0
    s_mov_b64 exec, s[54:55]
    ds_read_b128 v[36:39], v6 offset:14336
    ds_read_b128 v[40:43], v6 offset:14848
    s_mov_b64 exec, -1
    v_exp_f32 v72, v72
    v_exp_f32 v73, v73
    v_exp_f32 v74, v74
    v_exp_f32 v75, v75
    v_cvt_pk_bf16_f32 v68, v68, v69
    v_cvt_pk_bf16_f32 v69, v70, v71
    v_cvt_pk_bf16_f32 v70, v72, v73
    v_cvt_pk_bf16_f32 v71, v74, v75
    v_exp_f32 v76, v76
    v_exp_f32 v77, v77
    v_mfma_f32_32x32x16_bf16 v[84:99], v[44:47], v[68:71], v[84:99]
    v_exp_f32 v78, v78
    v_exp_f32 v79, v79
    v_exp_f32 v80, v80
    v_exp_f32 v81, v81
    v_exp_f32 v82, v82
    v_exp_f32 v83, v83
    v_cvt_pk_bf16_f32 v72, v76, v77
    v_cvt_pk_bf16_f32 v73, v78, v79
    v_cvt_pk_bf16_f32 v74, v80, v81
    v_cvt_pk_bf16_f32 v75, v82, v83
    v_exp_f32 v52, v52
    v_exp_f32 v53, v53
    v_mfma_f32_32x32x16_bf16 v[84:99], v[48:51], v[72:75], v[84:99]
    s_waitcnt lgkmcnt(0)
    ds_read_b128 v[28:31], v4 offset:18432
    v_exp_f32 v54, v54
    v_exp_f32 v55, v55
    v_mfma_f32_32x32x16_bf16 v[68:83], v[32:35], v[24:27], 0
    s_mov_b64 exec, s[54:55]
    ds_read_b128 v[44:47], v6 offset:16384
    ds_read_b128 v[48:51], v6 offset:16896
    s_mov_b64 exec, -1
    v_exp_f32 v56, v56
    v_exp_f32 v57, v57
    v_exp_f32 v58, v58
    v_exp_f32 v59, v59
    v_cvt_pk_bf16_f32 v52, v52, v53
    v_cvt_pk_bf16_f32 v53, v54, v55
    v_cvt_pk_bf16_f32 v54, v56, v57
    v_cvt_pk_bf16_f32 v55, v58, v59
    v_exp_f32 v60, v60
    v_exp_f32 v61, v61
    v_mfma_f32_32x32x16_bf16 v[84:99], v[36:39], v[52:55], v[84:99]
    buffer_load_dwordx4 v[100:103], v3, s[36:39], s50 offen offset:0
    v_exp_f32 v62, v62
    v_exp_f32 v63, v63
    v_exp_f32 v64, v64
    v_exp_f32 v65, v65
    v_exp_f32 v66, v66
    v_exp_f32 v67, v67
    v_cvt_pk_bf16_f32 v56, v60, v61
    v_cvt_pk_bf16_f32 v57, v62, v63
    v_cvt_pk_bf16_f32 v58, v64, v65
    v_cvt_pk_bf16_f32 v59, v66, v67
    v_exp_f32 v68, v68
    v_exp_f32 v69, v69
    v_mfma_f32_32x32x16_bf16 v[84:99], v[40:43], v[56:59], v[84:99]
    s_waitcnt lgkmcnt(0)
    ds_read_b128 v[32:35], v4 offset:20480
    v_exp_f32 v70, v70
    v_exp_f32 v71, v71
    v_mfma_f32_32x32x16_bf16 v[52:67], v[28:31], v[24:27], 0
    s_mov_b64 exec, s[54:55]
    ds_read_b128 v[36:39], v6 offset:18432
    ds_read_b128 v[40:43], v6 offset:18944
    s_mov_b64 exec, -1
    v_exp_f32 v72, v72
    v_exp_f32 v73, v73
    v_exp_f32 v74, v74
    v_exp_f32 v75, v75
    v_cvt_pk_bf16_f32 v68, v68, v69
    v_cvt_pk_bf16_f32 v69, v70, v71
    v_cvt_pk_bf16_f32 v70, v72, v73
    v_cvt_pk_bf16_f32 v71, v74, v75
    v_exp_f32 v76, v76
    v_exp_f32 v77, v77
    v_mfma_f32_32x32x16_bf16 v[84:99], v[44:47], v[68:71], v[84:99]
    buffer_load_dwordx4 v[104:107], v3, s[36:39], s50 offen offset:1024
    v_exp_f32 v78, v78
    v_exp_f32 v79, v79
    v_exp_f32 v80, v80
    v_exp_f32 v81, v81
    v_exp_f32 v82, v82
    v_exp_f32 v83, v83
    v_cvt_pk_bf16_f32 v72, v76, v77
    v_cvt_pk_bf16_f32 v73, v78, v79
    v_cvt_pk_bf16_f32 v74, v80, v81
    v_cvt_pk_bf16_f32 v75, v82, v83
    v_exp_f32 v52, v52
    v_exp_f32 v53, v53
    v_mfma_f32_32x32x16_bf16 v[84:99], v[48:51], v[72:75], v[84:99]
    s_waitcnt lgkmcnt(0)
    ds_read_b128 v[28:31], v4 offset:22528
    v_exp_f32 v54, v54
    v_exp_f32 v55, v55
    v_mfma_f32_32x32x16_bf16 v[68:83], v[32:35], v[24:27], 0
    s_mov_b64 exec, s[54:55]
    ds_read_b128 v[44:47], v6 offset:20480
    ds_read_b128 v[48:51], v6 offset:20992
    s_mov_b64 exec, -1
    v_exp_f32 v56, v56
    v_exp_f32 v57, v57
    v_exp_f32 v58, v58
    v_exp_f32 v59, v59
    v_cvt_pk_bf16_f32 v52, v52, v53
    v_cvt_pk_bf16_f32 v53, v54, v55
    v_cvt_pk_bf16_f32 v54, v56, v57
    v_cvt_pk_bf16_f32 v55, v58, v59
    v_exp_f32 v60, v60
    v_exp_f32 v61, v61
    v_mfma_f32_32x32x16_bf16 v[84:99], v[36:39], v[52:55], v[84:99]
    buffer_load_dwordx4 v[108:111], v3, s[36:39], s50 offen offset:2048
    v_exp_f32 v62, v62
    v_exp_f32 v63, v63
    v_exp_f32 v64, v64
    v_exp_f32 v65, v65
    v_exp_f32 v66, v66
    v_exp_f32 v67, v67
    v_cvt_pk_bf16_f32 v56, v60, v61
    v_cvt_pk_bf16_f32 v57, v62, v63
    v_cvt_pk_bf16_f32 v58, v64, v65
    v_cvt_pk_bf16_f32 v59, v66, v67
    v_exp_f32 v68, v68
    v_exp_f32 v69, v69
    v_mfma_f32_32x32x16_bf16 v[84:99], v[40:43], v[56:59], v[84:99]
    s_waitcnt lgkmcnt(0)
    ds_read_b128 v[32:35], v4 offset:24576
    v_exp_f32 v70, v70
    v_exp_f32 v71, v71
    v_mfma_f32_32x32x16_bf16 v[52:67], v[28:31], v[24:27], 0
    s_mov_b64 exec, s[54:55]
    ds_read_b128 v[36:39], v6 offset:22528
    ds_read_b128 v[40:43], v6 offset:23040
    s_mov_b64 exec, -1
    v_exp_f32 v72, v72
    v_exp_f32 v73, v73
    v_exp_f32 v74, v74
    v_exp_f32 v75, v75
    v_cvt_pk_bf16_f32 v68, v68, v69
    v_cvt_pk_bf16_f32 v69, v70, v71
    v_cvt_pk_bf16_f32 v70, v72, v73
    v_cvt_pk_bf16_f32 v71, v74, v75
    v_exp_f32 v76, v76
    v_exp_f32 v77, v77
    v_mfma_f32_32x32x16_bf16 v[84:99], v[44:47], v[68:71], v[84:99]
    buffer_load_dwordx4 v[112:115], v3, s[36:39], s50 offen offset:3072
    s_add_u32 s50, s50, 4096
    v_exp_f32 v78, v78
    v_exp_f32 v79, v79
    v_exp_f32 v80, v80
    v_exp_f32 v81, v81
    v_exp_f32 v82, v82
    v_exp_f32 v83, v83
    v_cvt_pk_bf16_f32 v72, v76, v77
    v_cvt_pk_bf16_f32 v73, v78, v79
    v_cvt_pk_bf16_f32 v74, v80, v81
    v_cvt_pk_bf16_f32 v75, v82, v83
    v_exp_f32 v52, v52
    v_exp_f32 v53, v53
    v_mfma_f32_32x32x16_bf16 v[84:99], v[48:51], v[72:75], v[84:99]
    s_waitcnt lgkmcnt(0)
    ds_read_b128 v[28:31], v4 offset:26624
    v_exp_f32 v54, v54
    v_exp_f32 v55, v55
    v_mfma_f32_32x32x16_bf16 v[68:83], v[32:35], v[24:27], 0
    s_mov_b64 exec, s[54:55]
    ds_read_b128 v[44:47], v6 offset:24576
    ds_read_b128 v[48:51], v6 offset:25088
    s_mov_b64 exec, -1
    v_exp_f32 v56, v56
    v_exp_f32 v57, v57
    v_exp_f32 v58, v58
    v_exp_f32 v59, v59
    v_cvt_pk_bf16_f32 v52, v52, v53
    v_cvt_pk_bf16_f32 v53, v54, v55
    v_cvt_pk_bf16_f32 v54, v56, v57
    v_cvt_pk_bf16_f32 v55, v58, v59
    v_exp_f32 v60, v60
    v_exp_f32 v61, v61
    v_mfma_f32_32x32x16_bf16 v[84:99], v[36:39], v[52:55], v[84:99]
    buffer_load_dwordx4 v[116:119], v3, s[36:39], s50 offen offset:0
    v_exp_f32 v62, v62
    v_exp_f32 v63, v63
    v_exp_f32 v64, v64
    v_exp_f32 v65, v65
    v_exp_f32 v66, v66
    v_exp_f32 v67, v67
    v_cvt_pk_bf16_f32 v56, v60, v61
    v_cvt_pk_bf16_f32 v57, v62, v63
    v_cvt_pk_bf16_f32 v58, v64, v65
    v_cvt_pk_bf16_f32 v59, v66, v67
    v_exp_f32 v68, v68
    v_exp_f32 v69, v69
    v_mfma_f32_32x32x16_bf16 v[84:99], v[40:43], v[56:59], v[84:99]
    s_waitcnt lgkmcnt(0)
    ds_read_b128 v[32:35], v4 offset:28672
    v_exp_f32 v70, v70
    v_exp_f32 v71, v71
    v_mfma_f32_32x32x16_bf16 v[52:67], v[28:31], v[24:27], 0
    s_mov_b64 exec, s[54:55]
    ds_read_b128 v[36:39], v6 offset:26624
    ds_read_b128 v[40:43], v6 offset:27136
    s_mov_b64 exec, -1
    v_exp_f32 v72, v72
    v_exp_f32 v73, v73
    v_exp_f32 v74, v74
    v_exp_f32 v75, v75
    v_cvt_pk_bf16_f32 v68, v68, v69
    v_cvt_pk_bf16_f32 v69, v70, v71
    v_cvt_pk_bf16_f32 v70, v72, v73
    v_cvt_pk_bf16_f32 v71, v74, v75
    v_exp_f32 v76, v76
    v_exp_f32 v77, v77
    v_mfma_f32_32x32x16_bf16 v[84:99], v[44:47], v[68:71], v[84:99]
    buffer_load_dwordx4 v[120:123], v3, s[36:39], s50 offen offset:1024
    v_exp_f32 v78, v78
    v_exp_f32 v79, v79
    v_exp_f32 v80, v80
    v_exp_f32 v81, v81
    v_exp_f32 v82, v82
    v_exp_f32 v83, v83
    v_cvt_pk_bf16_f32 v72, v76, v77
    v_cvt_pk_bf16_f32 v73, v78, v79
    v_cvt_pk_bf16_f32 v74, v80, v81
    v_cvt_pk_bf16_f32 v75, v82, v83
    v_exp_f32 v52, v52
    v_exp_f32 v53, v53
    v_mfma_f32_32x32x16_bf16 v[84:99], v[48:51], v[72:75], v[84:99]
    s_waitcnt lgkmcnt(0)
    ds_read_b128 v[28:31], v4 offset:30720
    v_exp_f32 v54, v54
    v_exp_f32 v55, v55
    v_mfma_f32_32x32x16_bf16 v[68:83], v[32:35], v[24:27], 0
    s_mov_b64 exec, s[54:55]
    ds_read_b128 v[44:47], v6 offset:28672
    ds_read_b128 v[48:51], v6 offset:29184
    s_mov_b64 exec, -1
    v_exp_f32 v56, v56
    v_exp_f32 v57, v57
    v_exp_f32 v58, v58
    v_exp_f32 v59, v59
    v_cvt_pk_bf16_f32 v52, v52, v53
    v_cvt_pk_bf16_f32 v53, v54, v55
    v_cvt_pk_bf16_f32 v54, v56, v57
    v_cvt_pk_bf16_f32 v55, v58, v59
    v_exp_f32 v60, v60
    v_exp_f32 v61, v61
    v_mfma_f32_32x32x16_bf16 v[84:99], v[36:39], v[52:55], v[84:99]
    buffer_load_dwordx4 v[124:127], v3, s[36:39], s50 offen offset:2048
    v_exp_f32 v62, v62
    v_exp_f32 v63, v63
    v_exp_f32 v64, v64
    v_exp_f32 v65, v65
    v_exp_f32 v66, v66
    v_exp_f32 v67, v67
    v_cvt_pk_bf16_f32 v56, v60, v61
    v_cvt_pk_bf16_f32 v57, v62, v63
    v_cvt_pk_bf16_f32 v58, v64, v65
    v_cvt_pk_bf16_f32 v59, v66, v67
    v_exp_f32 v68, v68
    v_exp_f32 v69, v69
    v_mfma_f32_32x32x16_bf16 v[84:99], v[40:43], v[56:59], v[84:99]
    s_waitcnt lgkmcnt(0)
    ds_read_b128 v[32:35], v4 offset:32768
    v_exp_f32 v70, v70
    v_exp_f32 v71, v71
    v_mfma_f32_32x32x16_bf16 v[52:67], v[28:31], v[24:27], 0
    s_mov_b64 exec, s[54:55]
    ds_read_b128 v[36:39], v6 offset:30720
    ds_read_b128 v[40:43], v6 offset:31232
    s_mov_b64 exec, -1
    v_exp_f32 v72, v72
    v_exp_f32 v73, v73
    v_exp_f32 v74, v74
    v_exp_f32 v75, v75
    v_cvt_pk_bf16_f32 v68, v68, v69
    v_cvt_pk_bf16_f32 v69, v70, v71
    v_cvt_pk_bf16_f32 v70, v72, v73
    v_cvt_pk_bf16_f32 v71, v74, v75
    v_exp_f32 v76, v76
    v_exp_f32 v77, v77
    v_mfma_f32_32x32x16_bf16 v[84:99], v[44:47], v[68:71], v[84:99]
    buffer_load_dwordx4 v[128:131], v3, s[36:39], s50 offen offset:3072
    s_add_u32 s50, s50, 4096
    v_exp_f32 v78, v78
    v_exp_f32 v79, v79
    v_exp_f32 v80, v80
    v_exp_f32 v81, v81
    v_exp_f32 v82, v82
    v_exp_f32 v83, v83
    v_cvt_pk_bf16_f32 v72, v76, v77
    v_cvt_pk_bf16_f32 v73, v78, v79
    v_cvt_pk_bf16_f32 v74, v80, v81
    v_cvt_pk_bf16_f32 v75, v82, v83
    v_exp_f32 v52, v52
    v_exp_f32 v53, v53
    v_mfma_f32_32x32x16_bf16 v[84:99], v[48:51], v[72:75], v[84:99]
    s_waitcnt lgkmcnt(0)
    ds_read_b128 v[28:31], v4 offset:34816
    v_exp_f32 v54, v54
    v_exp_f32 v55, v55
    v_mfma_f32_32x32x16_bf16 v[68:83], v[32:35], v[24:27], 0
    s_mov_b64 exec, s[54:55]
    ds_read_b128 v[44:47], v6 offset:32768
    ds_read_b128 v[48:51], v6 offset:33280
    s_mov_b64 exec, -1
    v_exp_f32 v56, v56
    v_exp_f32 v57, v57
    v_exp_f32 v58, v58
    v_exp_f32 v59, v59
    v_cvt_pk_bf16_f32 v52, v52, v53
    v_cvt_pk_bf16_f32 v53, v54, v55
    v_cvt_pk_bf16_f32 v54, v56, v57
    v_cvt_pk_bf16_f32 v55, v58, v59
    v_exp_f32 v60, v60
    v_exp_f32 v61, v61
    v_mfma_f32_32x32x16_bf16 v[84:99], v[36:39], v[52:55], v[84:99]
    buffer_load_dwordx4 v[132:135], v3, s[36:39], s50 offen offset:0
    v_exp_f32 v62, v62
    v_exp_f32 v63, v63
    v_exp_f32 v64, v64
    v_exp_f32 v65, v65
    v_exp_f32 v66, v66
    v_exp_f32 v67, v67
    v_cvt_pk_bf16_f32 v56, v60, v61
    v_cvt_pk_bf16_f32 v57, v62, v63
    v_cvt_pk_bf16_f32 v58, v64, v65
    v_cvt_pk_bf16_f32 v59, v66, v67
    v_exp_f32 v68, v68
    v_exp_f32 v69, v69
    v_mfma_f32_32x32x16_bf16 v[84:99], v[40:43], v[56:59], v[84:99]
    s_waitcnt lgkmcnt(0)
    ds_read_b128 v[32:35], v4 offset:36864
    v_exp_f32 v70, v70
    v_exp_f32 v71, v71
    v_mfma_f32_32x32x16_bf16 v[52:67], v[28:31], v[24:27], 0
    s_mov_b64 exec, s[54:55]
    ds_read_b128 v[36:39], v6 offset:34816
    ds_read_b128 v[40:43], v6 offset:35328
    s_mov_b64 exec, -1
    v_exp_f32 v72, v72
    v_exp_f32 v73, v73
    v_exp_f32 v74, v74
    v_exp_f32 v75, v75
    v_cvt_pk_bf16_f32 v68, v68, v69
    v_cvt_pk_bf16_f32 v69, v70, v71
    v_cvt_pk_bf16_f32 v70, v72, v73
    v_cvt_pk_bf16_f32 v71, v74, v75
    v_exp_f32 v76, v76
    v_exp_f32 v77, v77
    v_mfma_f32_32x32x16_bf16 v[84:99], v[44:47], v[68:71], v[84:99]
    buffer_load_dwordx4 v[136:139], v3, s[36:39], s50 offen offset:1024
    v_exp_f32 v78, v78
    v_exp_f32 v79, v79
    v_exp_f32 v80, v80
    v_exp_f32 v81, v81
    v_exp_f32 v82, v82
    v_exp_f32 v83, v83
    v_cvt_pk_bf16_f32 v72, v76, v77
    v_cvt_pk_bf16_f32 v73, v78, v79
    v_cvt_pk_bf16_f32 v74, v80, v81
    v_cvt_pk_bf16_f32 v75, v82, v83
    v_exp_f32 v52, v52
    v_exp_f32 v53, v53
    v_mfma_f32_32x32x16_bf16 v[84:99], v[48:51], v[72:75], v[84:99]
    s_waitcnt lgkmcnt(0)
    ds_read_b128 v[28:31], v4 offset:38912
    v_exp_f32 v54, v54
    v_exp_f32 v55, v55
    v_mfma_f32_32x32x16_bf16 v[68:83], v[32:35], v[24:27], 0
    s_mov_b64 exec, s[54:55]
    ds_read_b128 v[44:47], v6 offset:36864
    ds_read_b128 v[48:51], v6 offset:37376
    s_mov_b64 exec, -1
    v_exp_f32 v56, v56
    v_exp_f32 v57, v57
    v_exp_f32 v58, v58
    v_exp_f32 v59, v59
    v_cvt_pk_bf16_f32 v52, v52, v53
    v_cvt_pk_bf16_f32 v53, v54, v55
    v_cvt_pk_bf16_f32 v54, v56, v57
    v_cvt_pk_bf16_f32 v55, v58, v59
    v_exp_f32 v60, v60
    v_exp_f32 v61, v61
    v_mfma_f32_32x32x16_bf16 v[84:99], v[36:39], v[52:55], v[84:99]
    buffer_load_dwordx4 v[140:143], v3, s[36:39], s50 offen offset:2048
    v_exp_f32 v62, v62
    v_exp_f32 v63, v63
    v_exp_f32 v64, v64
    v_exp_f32 v65, v65
    v_exp_f32 v66, v66
    v_exp_f32 v67, v67
    v_cvt_pk_bf16_f32 v56, v60, v61
    v_cvt_pk_bf16_f32 v57, v62, v63
    v_cvt_pk_bf16_f32 v58, v64, v65
    v_cvt_pk_bf16_f32 v59, v66, v67
    v_exp_f32 v68, v68
    v_exp_f32 v69, v69
    v_mfma_f32_32x32x16_bf16 v[84:99], v[40:43], v[56:59], v[84:99]
    s_waitcnt lgkmcnt(0)
    ds_read_b128 v[32:35], v4 offset:40960
    v_exp_f32 v70, v70
    v_exp_f32 v71, v71
    v_mfma_f32_32x32x16_bf16 v[52:67], v[28:31], v[24:27], 0
    s_mov_b64 exec, s[54:55]
    ds_read_b128 v[36:39], v6 offset:38912
    ds_read_b128 v[40:43], v6 offset:39424
    s_mov_b64 exec, -1
    v_exp_f32 v72, v72
    v_exp_f32 v73, v73
    v_exp_f32 v74, v74
    v_exp_f32 v75, v75
    v_cvt_pk_bf16_f32 v68, v68, v69
    v_cvt_pk_bf16_f32 v69, v70, v71
    v_cvt_pk_bf16_f32 v70, v72, v73
    v_cvt_pk_bf16_f32 v71, v74, v75
    v_exp_f32 v76, v76
    v_exp_f32 v77, v77
    v_mfma_f32_32x32x16_bf16 v[84:99], v[44:47], v[68:71], v[84:99]
    buffer_load_dwordx4 v[144:147], v3, s[36:39], s50 offen offset:3072
    s_add_u32 s50, s50, 4096
    v_exp_f32 v78, v78
    v_exp_f32 v79, v79
    v_exp_f32 v80, v80
    v_exp_f32 v81, v81
    v_exp_f32 v82, v82
    v_exp_f32 v83, v83
    v_cvt_pk_bf16_f32 v72, v76, v77
    v_cvt_pk_bf16_f32 v73, v78, v79
    v_cvt_pk_bf16_f32 v74, v80, v81
    v_cvt_pk_bf16_f32 v75, v82, v83
    v_exp_f32 v52, v52
    v_exp_f32 v53, v53
    v_mfma_f32_32x32x16_bf16 v[84:99], v[48:51], v[72:75], v[84:99]
    s_waitcnt lgkmcnt(0)
    ds_read_b128 v[28:31], v4 offset:43008
    v_exp_f32 v54, v54
    v_exp_f32 v55, v55
    v_mfma_f32_32x32x16_bf16 v[68:83], v[32:35], v[24:27], 0
    s_mov_b64 exec, s[54:55]
    ds_read_b128 v[44:47], v6 offset:40960
    ds_read_b128 v[48:51], v6 offset:41472
    s_mov_b64 exec, -1
    v_exp_f32 v56, v56
    v_exp_f32 v57, v57
    v_exp_f32 v58, v58
    v_exp_f32 v59, v59
    v_cvt_pk_bf16_f32 v52, v52, v53
    v_cvt_pk_bf16_f32 v53, v54, v55
    v_cvt_pk_bf16_f32 v54, v56, v57
    v_cvt_pk_bf16_f32 v55, v58, v59
    v_exp_f32 v60, v60
    v_exp_f32 v61, v61
    v_mfma_f32_32x32x16_bf16 v[84:99], v[36:39], v[52:55], v[84:99]
    buffer_load_dwordx4 v[148:151], v3, s[36:39], s50 offen offset:0
    v_exp_f32 v62, v62
    v_exp_f32 v63, v63
    v_exp_f32 v64, v64
    v_exp_f32 v65, v65
    v_exp_f32 v66, v66
    v_exp_f32 v67, v67
    v_cvt_pk_bf16_f32 v56, v60, v61
    v_cvt_pk_bf16_f32 v57, v62, v63
    v_cvt_pk_bf16_f32 v58, v64, v65
    v_cvt_pk_bf16_f32 v59, v66, v67
    v_exp_f32 v68, v68
    v_exp_f32 v69, v69
    v_mfma_f32_32x32x16_bf16 v[84:99], v[40:43], v[56:59], v[84:99]
    s_waitcnt lgkmcnt(0)
    ds_read_b128 v[32:35], v4 offset:45056
    v_exp_f32 v70, v70
    v_exp_f32 v71, v71
    v_mfma_f32_32x32x16_bf16 v[52:67], v[28:31], v[24:27], 0
    s_mov_b64 exec, s[54:55]
    ds_read_b128 v[36:39], v6 offset:43008
    ds_read_b128 v[40:43], v6 offset:43520
    s_mov_b64 exec, -1
    v_exp_f32 v72, v72
    v_exp_f32 v73, v73
    v_exp_f32 v74, v74
    v_exp_f32 v75, v75
    v_cvt_pk_bf16_f32 v68, v68, v69
    v_cvt_pk_bf16_f32 v69, v70, v71
    v_cvt_pk_bf16_f32 v70, v72, v73
    v_cvt_pk_bf16_f32 v71, v74, v75
    v_exp_f32 v76, v76
    v_exp_f32 v77, v77
    v_mfma_f32_32x32x16_bf16 v[84:99], v[44:47], v[68:71], v[84:99]
    buffer_load_dwordx4 v[152:155], v3, s[36:39], s50 offen offset:1024
    v_exp_f32 v78, v78
    v_exp_f32 v79, v79
    v_exp_f32 v80, v80
    v_exp_f32 v81, v81
    v_exp_f32 v82, v82
    v_exp_f32 v83, v83
    v_cvt_pk_bf16_f32 v72, v76, v77
    v_cvt_pk_bf16_f32 v73, v78, v79
    v_cvt_pk_bf16_f32 v74, v80, v81
    v_cvt_pk_bf16_f32 v75, v82, v83
    v_exp_f32 v52, v52
    v_exp_f32 v53, v53
    v_mfma_f32_32x32x16_bf16 v[84:99], v[48:51], v[72:75], v[84:99]
    s_waitcnt lgkmcnt(0)
    ds_read_b128 v[28:31], v4 offset:47104
    v_exp_f32 v54, v54
    v_exp_f32 v55, v55
    v_mfma_f32_32x32x16_bf16 v[68:83], v[32:35], v[24:27], 0
    s_mov_b64 exec, s[54:55]
    ds_read_b128 v[44:47], v6 offset:45056
    ds_read_b128 v[48:51], v6 offset:45568
    s_mov_b64 exec, -1
    v_exp_f32 v56, v56
    v_exp_f32 v57, v57
    v_exp_f32 v58, v58
    v_exp_f32 v59, v59
    v_cvt_pk_bf16_f32 v52, v52, v53
    v_cvt_pk_bf16_f32 v53, v54, v55
    v_cvt_pk_bf16_f32 v54, v56, v57
    v_cvt_pk_bf16_f32 v55, v58, v59
    v_exp_f32 v60, v60
    v_exp_f32 v61, v61
    v_mfma_f32_32x32x16_bf16 v[84:99], v[36:39], v[52:55], v[84:99]
    buffer_load_dwordx4 v[156:159], v3, s[36:39], s50 offen offset:2048
    v_exp_f32 v62, v62
    v_exp_f32 v63, v63
    v_exp_f32 v64, v64
    v_exp_f32 v65, v65
    v_exp_f32 v66, v66
    v_exp_f32 v67, v67
    v_cvt_pk_bf16_f32 v56, v60, v61
    v_cvt_pk_bf16_f32 v57, v62, v63
    v_cvt_pk_bf16_f32 v58, v64, v65
    v_cvt_pk_bf16_f32 v59, v66, v67
    v_exp_f32 v68, v68
    v_exp_f32 v69, v69
    v_mfma_f32_32x32x16_bf16 v[84:99], v[40:43], v[56:59], v[84:99]
    s_waitcnt lgkmcnt(0)
    ds_read_b128 v[32:35], v4 offset:49152
    v_exp_f32 v70, v70
    v_exp_f32 v71, v71
    v_mfma_f32_32x32x16_bf16 v[52:67], v[28:31], v[24:27], 0
    s_mov_b64 exec, s[54:55]
    ds_read_b128 v[36:39], v6 offset:47104
    ds_read_b128 v[40:43], v6 offset:47616
    s_mov_b64 exec, -1
    v_exp_f32 v72, v72
    v_exp_f32 v73, v73
    v_exp_f32 v74, v74
    v_exp_f32 v75, v75
    v_cvt_pk_bf16_f32 v68, v68, v69
    v_cvt_pk_bf16_f32 v69, v70, v71
    v_cvt_pk_bf16_f32 v70, v72, v73
    v_cvt_pk_bf16_f32 v71, v74, v75
    v_exp_f32 v76, v76
    v_exp_f32 v77, v77
    v_mfma_f32_32x32x16_bf16 v[84:99], v[44:47], v[68:71], v[84:99]
    buffer_load_dwordx4 v[160:163], v3, s[36:39], s50 offen offset:3072
    s_add_u32 s50, s50, 4096
    v_exp_f32 v78, v78
    v_exp_f32 v79, v79
    v_exp_f32 v80, v80
    v_exp_f32 v81, v81
    v_exp_f32 v82, v82
    v_exp_f32 v83, v83
    v_cvt_pk_bf16_f32 v72, v76, v77
    v_cvt_pk_bf16_f32 v73, v78, v79
    v_cvt_pk_bf16_f32 v74, v80, v81
    v_cvt_pk_bf16_f32 v75, v82, v83
    v_exp_f32 v52, v52
    v_exp_f32 v53, v53
    v_mfma_f32_32x32x16_bf16 v[84:99], v[48:51], v[72:75], v[84:99]
    s_waitcnt lgkmcnt(0)
    ds_read_b128 v[28:31], v4 offset:51200
    v_exp_f32 v54, v54
    v_exp_f32 v55, v55
    v_mfma_f32_32x32x16_bf16 v[68:83], v[32:35], v[24:27], 0
    s_mov_b64 exec, s[54:55]
    ds_read_b128 v[44:47], v6 offset:49152
    ds_read_b128 v[48:51], v6 offset:49664
    s_mov_b64 exec, -1
    v_exp_f32 v56, v56
    v_exp_f32 v57, v57
    v_exp_f32 v58, v58
    v_exp_f32 v59, v59
    v_cvt_pk_bf16_f32 v52, v52, v53
    v_cvt_pk_bf16_f32 v53, v54, v55
    v_cvt_pk_bf16_f32 v54, v56, v57
    v_cvt_pk_bf16_f32 v55, v58, v59
    v_exp_f32 v60, v60
    v_exp_f32 v61, v61
    v_mfma_f32_32x32x16_bf16 v[84:99], v[36:39], v[52:55], v[84:99]
    buffer_load_dwordx4 v[164:167], v3, s[36:39], s51 offen offset:0
    v_exp_f32 v62, v62
    v_exp_f32 v63, v63
    v_exp_f32 v64, v64
    v_exp_f32 v65, v65
    v_exp_f32 v66, v66
    v_exp_f32 v67, v67
    v_cvt_pk_bf16_f32 v56, v60, v61
    v_cvt_pk_bf16_f32 v57, v62, v63
    v_cvt_pk_bf16_f32 v58, v64, v65
    v_cvt_pk_bf16_f32 v59, v66, v67
    v_exp_f32 v68, v68
    v_exp_f32 v69, v69
    v_mfma_f32_32x32x16_bf16 v[84:99], v[40:43], v[56:59], v[84:99]
    s_waitcnt lgkmcnt(0)
    ds_read_b128 v[32:35], v4 offset:53248
    v_exp_f32 v70, v70
    v_exp_f32 v71, v71
    v_mfma_f32_32x32x16_bf16 v[52:67], v[28:31], v[24:27], 0
    s_mov_b64 exec, s[54:55]
    ds_read_b128 v[36:39], v6 offset:51200
    ds_read_b128 v[40:43], v6 offset:51712
    s_mov_b64 exec, -1
    v_exp_f32 v72, v72
    v_exp_f32 v73, v73
    v_exp_f32 v74, v74
    v_exp_f32 v75, v75
    v_cvt_pk_bf16_f32 v68, v68, v69
    v_cvt_pk_bf16_f32 v69, v70, v71
    v_cvt_pk_bf16_f32 v70, v72, v73
    v_cvt_pk_bf16_f32 v71, v74, v75
    v_exp_f32 v76, v76
    v_exp_f32 v77, v77
    v_mfma_f32_32x32x16_bf16 v[84:99], v[44:47], v[68:71], v[84:99]
    buffer_load_dwordx4 v[168:171], v3, s[36:39], s51 offen offset:1024
    v_exp_f32 v78, v78
    v_exp_f32 v79, v79
    v_exp_f32 v80, v80
    v_exp_f32 v81, v81
    v_exp_f32 v82, v82
    v_exp_f32 v83, v83
    v_cvt_pk_bf16_f32 v72, v76, v77
    v_cvt_pk_bf16_f32 v73, v78, v79
    v_cvt_pk_bf16_f32 v74, v80, v81
    v_cvt_pk_bf16_f32 v75, v82, v83
    v_exp_f32 v52, v52
    v_exp_f32 v53, v53
    v_mfma_f32_32x32x16_bf16 v[84:99], v[48:51], v[72:75], v[84:99]
    s_waitcnt lgkmcnt(0)
    ds_read_b128 v[28:31], v4 offset:55296
    v_exp_f32 v54, v54
    v_exp_f32 v55, v55
    v_mfma_f32_32x32x16_bf16 v[68:83], v[32:35], v[24:27], 0
    s_mov_b64 exec, s[54:55]
    ds_read_b128 v[44:47], v6 offset:53248
    ds_read_b128 v[48:51], v6 offset:53760
    s_mov_b64 exec, -1
    v_exp_f32 v56, v56
    v_exp_f32 v57, v57
    v_exp_f32 v58, v58
    v_exp_f32 v59, v59
    v_cvt_pk_bf16_f32 v52, v52, v53
    v_cvt_pk_bf16_f32 v53, v54, v55
    v_cvt_pk_bf16_f32 v54, v56, v57
    v_cvt_pk_bf16_f32 v55, v58, v59
    v_exp_f32 v60, v60
    v_exp_f32 v61, v61
    v_mfma_f32_32x32x16_bf16 v[84:99], v[36:39], v[52:55], v[84:99]
    buffer_load_dwordx4 v[172:175], v3, s[36:39], s51 offen offset:2048
    v_exp_f32 v62, v62
    v_exp_f32 v63, v63
    v_exp_f32 v64, v64
    v_exp_f32 v65, v65
    v_exp_f32 v66, v66
    v_exp_f32 v67, v67
    v_cvt_pk_bf16_f32 v56, v60, v61
    v_cvt_pk_bf16_f32 v57, v62, v63
    v_cvt_pk_bf16_f32 v58, v64, v65
    v_cvt_pk_bf16_f32 v59, v66, v67
    v_exp_f32 v68, v68
    v_exp_f32 v69, v69
    v_mfma_f32_32x32x16_bf16 v[84:99], v[40:43], v[56:59], v[84:99]
    s_waitcnt lgkmcnt(0)
    ds_read_b128 v[32:35], v4 offset:57344
    v_exp_f32 v70, v70
    v_exp_f32 v71, v71
    v_mfma_f32_32x32x16_bf16 v[52:67], v[28:31], v[24:27], 0
    s_mov_b64 exec, s[54:55]
    ds_read_b128 v[36:39], v6 offset:55296
    ds_read_b128 v[40:43], v6 offset:55808
    s_mov_b64 exec, -1
    v_exp_f32 v72, v72
    v_exp_f32 v73, v73
    v_exp_f32 v74, v74
    v_exp_f32 v75, v75
    v_cvt_pk_bf16_f32 v68, v68, v69
    v_cvt_pk_bf16_f32 v69, v70, v71
    v_cvt_pk_bf16_f32 v70, v72, v73
    v_cvt_pk_bf16_f32 v71, v74, v75
    v_exp_f32 v76, v76
    v_exp_f32 v77, v77
    v_mfma_f32_32x32x16_bf16 v[84:99], v[44:47], v[68:71], v[84:99]
    buffer_load_dwordx4 v[176:179], v3, s[36:39], s51 offen offset:3072
    s_add_u32 s51, s51, 4096
    v_exp_f32 v78, v78
    v_exp_f32 v79, v79
    v_exp_f32 v80, v80
    v_exp_f32 v81, v81
    v_exp_f32 v82, v82
    v_exp_f32 v83, v83
    v_cvt_pk_bf16_f32 v72, v76, v77
    v_cvt_pk_bf16_f32 v73, v78, v79
    v_cvt_pk_bf16_f32 v74, v80, v81
    v_cvt_pk_bf16_f32 v75, v82, v83
    v_exp_f32 v52, v52
    v_exp_f32 v53, v53
    v_mfma_f32_32x32x16_bf16 v[84:99], v[48:51], v[72:75], v[84:99]
    s_waitcnt lgkmcnt(0)
    ds_read_b128 v[28:31], v4 offset:59392
    v_exp_f32 v54, v54
    v_exp_f32 v55, v55
    v_mfma_f32_32x32x16_bf16 v[68:83], v[32:35], v[24:27], 0
    s_mov_b64 exec, s[54:55]
    ds_read_b128 v[44:47], v6 offset:57344
    ds_read_b128 v[48:51], v6 offset:57856
    s_mov_b64 exec, -1
    v_exp_f32 v56, v56
    v_exp_f32 v57, v57
    v_exp_f32 v58, v58
    v_exp_f32 v59, v59
    v_cvt_pk_bf16_f32 v52, v52, v53
    v_cvt_pk_bf16_f32 v53, v54, v55
    v_cvt_pk_bf16_f32 v54, v56, v57
    v_cvt_pk_bf16_f32 v55, v58, v59
    v_exp_f32 v60, v60
    v_exp_f32 v61, v61
    v_mfma_f32_32x32x16_bf16 v[84:99], v[36:39], v[52:55], v[84:99]
    buffer_load_dwordx4 v[180:183], v3, s[36:39], s51 offen offset:0
    v_exp_f32 v62, v62
    v_exp_f32 v63, v63
    v_exp_f32 v64, v64
    v_exp_f32 v65, v65
    v_exp_f32 v66, v66
    v_exp_f32 v67, v67
    v_cvt_pk_bf16_f32 v56, v60, v61
    v_cvt_pk_bf16_f32 v57, v62, v63
    v_cvt_pk_bf16_f32 v58, v64, v65
    v_cvt_pk_bf16_f32 v59, v66, v67
    v_exp_f32 v68, v68
    v_exp_f32 v69, v69
    v_mfma_f32_32x32x16_bf16 v[84:99], v[40:43], v[56:59], v[84:99]
    s_waitcnt lgkmcnt(0)
    ds_read_b128 v[32:35], v4 offset:61440
    v_exp_f32 v70, v70
    v_exp_f32 v71, v71
    v_mfma_f32_32x32x16_bf16 v[52:67], v[28:31], v[24:27], 0
    s_mov_b64 exec, s[54:55]
    ds_read_b128 v[36:39], v6 offset:59392
    ds_read_b128 v[40:43], v6 offset:59904
    s_mov_b64 exec, -1
    v_exp_f32 v72, v72
    v_exp_f32 v73, v73
    v_exp_f32 v74, v74
    v_exp_f32 v75, v75
    v_cvt_pk_bf16_f32 v68, v68, v69
    v_cvt_pk_bf16_f32 v69, v70, v71
    v_cvt_pk_bf16_f32 v70, v72, v73
    v_cvt_pk_bf16_f32 v71, v74, v75
    v_exp_f32 v76, v76
    v_exp_f32 v77, v77
    v_mfma_f32_32x32x16_bf16 v[84:99], v[44:47], v[68:71], v[84:99]
    buffer_load_dwordx4 v[184:187], v3, s[36:39], s51 offen offset:1024
    v_exp_f32 v78, v78
    v_exp_f32 v79, v79
    v_exp_f32 v80, v80
    v_exp_f32 v81, v81
    v_exp_f32 v82, v82
    v_exp_f32 v83, v83
    v_cvt_pk_bf16_f32 v72, v76, v77
    v_cvt_pk_bf16_f32 v73, v78, v79
    v_cvt_pk_bf16_f32 v74, v80, v81
    v_cvt_pk_bf16_f32 v75, v82, v83
    v_exp_f32 v52, v52
    v_exp_f32 v53, v53
    v_mfma_f32_32x32x16_bf16 v[84:99], v[48:51], v[72:75], v[84:99]
    s_waitcnt lgkmcnt(0)
    ds_read_b128 v[28:31], v4 offset:63488
    v_exp_f32 v54, v54
    v_exp_f32 v55, v55
    v_mfma_f32_32x32x16_bf16 v[68:83], v[32:35], v[24:27], 0
    s_mov_b64 exec, s[54:55]
    ds_read_b128 v[44:47], v6 offset:61440
    ds_read_b128 v[48:51], v6 offset:61952
    s_mov_b64 exec, -1
    v_exp_f32 v56, v56
    v_exp_f32 v57, v57
    v_exp_f32 v58, v58
    v_exp_f32 v59, v59
    v_cvt_pk_bf16_f32 v52, v52, v53
    v_cvt_pk_bf16_f32 v53, v54, v55
    v_cvt_pk_bf16_f32 v54, v56, v57
    v_cvt_pk_bf16_f32 v55, v58, v59
    v_exp_f32 v60, v60
    v_exp_f32 v61, v61
    v_mfma_f32_32x32x16_bf16 v[84:99], v[36:39], v[52:55], v[84:99]
    buffer_load_dwordx4 v[188:191], v3, s[36:39], s51 offen offset:2048
    v_exp_f32 v62, v62
    v_exp_f32 v63, v63
    v_exp_f32 v64, v64
    v_exp_f32 v65, v65
    v_exp_f32 v66, v66
    v_exp_f32 v67, v67
    v_cvt_pk_bf16_f32 v56, v60, v61
    v_cvt_pk_bf16_f32 v57, v62, v63
    v_cvt_pk_bf16_f32 v58, v64, v65
    v_cvt_pk_bf16_f32 v59, v66, v67
    v_exp_f32 v68, v68
    v_exp_f32 v69, v69
    v_mfma_f32_32x32x16_bf16 v[84:99], v[40:43], v[56:59], v[84:99]
    s_waitcnt lgkmcnt(0)
    ds_read_b128 v[32:35], v5 offset:0
    v_exp_f32 v70, v70
    v_exp_f32 v71, v71
    v_mfma_f32_32x32x16_bf16 v[52:67], v[28:31], v[24:27], 0
    s_mov_b64 exec, s[54:55]
    ds_read_b128 v[36:39], v6 offset:63488
    ds_read_b128 v[40:43], v6 offset:64000
    s_mov_b64 exec, -1
    v_exp_f32 v72, v72
    v_exp_f32 v73, v73
    v_exp_f32 v74, v74
    v_exp_f32 v75, v75
    v_cvt_pk_bf16_f32 v68, v68, v69
    v_cvt_pk_bf16_f32 v69, v70, v71
    v_cvt_pk_bf16_f32 v70, v72, v73
    v_cvt_pk_bf16_f32 v71, v74, v75
    v_exp_f32 v76, v76
    v_exp_f32 v77, v77
    v_mfma_f32_32x32x16_bf16 v[84:99], v[44:47], v[68:71], v[84:99]
    buffer_load_dwordx4 v[192:195], v3, s[36:39], s51 offen offset:3072
    s_add_u32 s51, s51, 4096
    v_exp_f32 v78, v78
    v_exp_f32 v79, v79
    v_exp_f32 v80, v80
    v_exp_f32 v81, v81
    v_exp_f32 v82, v82
    v_exp_f32 v83, v83
    v_cvt_pk_bf16_f32 v72, v76, v77
    v_cvt_pk_bf16_f32 v73, v78, v79
    v_cvt_pk_bf16_f32 v74, v80, v81
    v_cvt_pk_bf16_f32 v75, v82, v83
    v_exp_f32 v52, v52
    v_exp_f32 v53, v53
    v_mfma_f32_32x32x16_bf16 v[84:99], v[48:51], v[72:75], v[84:99]
    s_waitcnt lgkmcnt(0)
    ds_read_b128 v[28:31], v5 offset:2048
    v_exp_f32 v54, v54
    v_exp_f32 v55, v55
    v_mfma_f32_32x32x16_bf16 v[68:83], v[32:35], v[24:27], 0
    s_mov_b64 exec, s[54:55]
    ds_read_b128 v[44:47], v7 offset:0
    ds_read_b128 v[48:51], v7 offset:512
    s_mov_b64 exec, -1
    v_exp_f32 v56, v56
    v_exp_f32 v57, v57
    v_exp_f32 v58, v58
    v_exp_f32 v59, v59
    v_cvt_pk_bf16_f32 v52, v52, v53
    v_cvt_pk_bf16_f32 v53, v54, v55
    v_cvt_pk_bf16_f32 v54, v56, v57
    v_cvt_pk_bf16_f32 v55, v58, v59
    v_exp_f32 v60, v60
    v_exp_f32 v61, v61
    v_mfma_f32_32x32x16_bf16 v[84:99], v[36:39], v[52:55], v[84:99]
    buffer_load_dwordx4 v[196:199], v3, s[36:39], s51 offen offset:0
    v_exp_f32 v62, v62
    v_exp_f32 v63, v63
    v_exp_f32 v64, v64
    v_exp_f32 v65, v65
    v_exp_f32 v66, v66
    v_exp_f32 v67, v67
    v_cvt_pk_bf16_f32 v56, v60, v61
    v_cvt_pk_bf16_f32 v57, v62, v63
    v_cvt_pk_bf16_f32 v58, v64, v65
    v_cvt_pk_bf16_f32 v59, v66, v67
    v_exp_f32 v68, v68
    v_exp_f32 v69, v69
    v_mfma_f32_32x32x16_bf16 v[84:99], v[40:43], v[56:59], v[84:99]
    s_waitcnt lgkmcnt(0)
    ds_read_b128 v[32:35], v5 offset:4096
    v_exp_f32 v70, v70
    v_exp_f32 v71, v71
    v_mfma_f32_32x32x16_bf16 v[52:67], v[28:31], v[24:27], 0
    s_mov_b64 exec, s[54:55]
    ds_read_b128 v[36:39], v7 offset:2048
    ds_read_b128 v[40:43], v7 offset:2560
    s_mov_b64 exec, -1
    v_exp_f32 v72, v72
    v_exp_f32 v73, v73
    v_exp_f32 v74, v74
    v_exp_f32 v75, v75
    v_cvt_pk_bf16_f32 v68, v68, v69
    v_cvt_pk_bf16_f32 v69, v70, v71
    v_cvt_pk_bf16_f32 v70, v72, v73
    v_cvt_pk_bf16_f32 v71, v74, v75
    v_exp_f32 v76, v76
    v_exp_f32 v77, v77
    v_mfma_f32_32x32x16_bf16 v[84:99], v[44:47], v[68:71], v[84:99]
    buffer_load_dwordx4 v[200:203], v3, s[36:39], s51 offen offset:1024
    v_exp_f32 v78, v78
    v_exp_f32 v79, v79
    v_exp_f32 v80, v80
    v_exp_f32 v81, v81
    v_exp_f32 v82, v82
    v_exp_f32 v83, v83
    v_cvt_pk_bf16_f32 v72, v76, v77
    v_cvt_pk_bf16_f32 v73, v78, v79
    v_cvt_pk_bf16_f32 v74, v80, v81
    v_cvt_pk_bf16_f32 v75, v82, v83
    v_exp_f32 v52, v52
    v_exp_f32 v53, v53
    v_mfma_f32_32x32x16_bf16 v[84:99], v[48:51], v[72:75], v[84:99]
    s_waitcnt lgkmcnt(0)
    ds_read_b128 v[28:31], v5 offset:6144
    v_exp_f32 v54, v54
    v_exp_f32 v55, v55
    v_mfma_f32_32x32x16_bf16 v[68:83], v[32:35], v[24:27], 0
    s_mov_b64 exec, s[54:55]
    ds_read_b128 v[44:47], v7 offset:4096
    ds_read_b128 v[48:51], v7 offset:4608
    s_mov_b64 exec, -1
    v_exp_f32 v56, v56
    v_exp_f32 v57, v57
    v_exp_f32 v58, v58
    v_exp_f32 v59, v59
    v_cvt_pk_bf16_f32 v52, v52, v53
    v_cvt_pk_bf16_f32 v53, v54, v55
    v_cvt_pk_bf16_f32 v54, v56, v57
    v_cvt_pk_bf16_f32 v55, v58, v59
    v_exp_f32 v60, v60
    v_exp_f32 v61, v61
    v_mfma_f32_32x32x16_bf16 v[84:99], v[36:39], v[52:55], v[84:99]
    buffer_load_dwordx4 v[204:207], v3, s[36:39], s51 offen offset:2048
    v_exp_f32 v62, v62
    v_exp_f32 v63, v63
    v_exp_f32 v64, v64
    v_exp_f32 v65, v65
    v_exp_f32 v66, v66
    v_exp_f32 v67, v67
    v_cvt_pk_bf16_f32 v56, v60, v61
    v_cvt_pk_bf16_f32 v57, v62, v63
    v_cvt_pk_bf16_f32 v58, v64, v65
    v_cvt_pk_bf16_f32 v59, v66, v67
    v_exp_f32 v68, v68
    v_exp_f32 v69, v69
    v_mfma_f32_32x32x16_bf16 v[84:99], v[40:43], v[56:59], v[84:99]
    s_waitcnt lgkmcnt(0)
    ds_read_b128 v[32:35], v5 offset:8192
    v_exp_f32 v70, v70
    v_exp_f32 v71, v71
    v_mfma_f32_32x32x16_bf16 v[52:67], v[28:31], v[24:27], 0
    s_mov_b64 exec, s[54:55]
    ds_read_b128 v[36:39], v7 offset:6144
    ds_read_b128 v[40:43], v7 offset:6656
    s_mov_b64 exec, -1
    v_exp_f32 v72, v72
    v_exp_f32 v73, v73
    v_exp_f32 v74, v74
    v_exp_f32 v75, v75
    v_cvt_pk_bf16_f32 v68, v68, v69
    v_cvt_pk_bf16_f32 v69, v70, v71
    v_cvt_pk_bf16_f32 v70, v72, v73
    v_cvt_pk_bf16_f32 v71, v74, v75
    v_exp_f32 v76, v76
    v_exp_f32 v77, v77
    v_mfma_f32_32x32x16_bf16 v[84:99], v[44:47], v[68:71], v[84:99]
    buffer_load_dwordx4 v[208:211], v3, s[36:39], s51 offen offset:3072
    s_add_u32 s51, s51, 4096
    v_exp_f32 v78, v78
    v_exp_f32 v79, v79
    v_exp_f32 v80, v80
    v_exp_f32 v81, v81
    v_exp_f32 v82, v82
    v_exp_f32 v83, v83
    v_cvt_pk_bf16_f32 v72, v76, v77
    v_cvt_pk_bf16_f32 v73, v78, v79
    v_cvt_pk_bf16_f32 v74, v80, v81
    v_cvt_pk_bf16_f32 v75, v82, v83
    v_exp_f32 v52, v52
    v_exp_f32 v53, v53
    v_mfma_f32_32x32x16_bf16 v[84:99], v[48:51], v[72:75], v[84:99]
    s_waitcnt lgkmcnt(0)
    ds_read_b128 v[28:31], v5 offset:10240
    v_exp_f32 v54, v54
    v_exp_f32 v55, v55
    v_mfma_f32_32x32x16_bf16 v[68:83], v[32:35], v[24:27], 0
    s_mov_b64 exec, s[54:55]
    ds_read_b128 v[44:47], v7 offset:8192
    ds_read_b128 v[48:51], v7 offset:8704
    s_mov_b64 exec, -1
    v_exp_f32 v56, v56
    v_exp_f32 v57, v57
    v_exp_f32 v58, v58
    v_exp_f32 v59, v59
    v_cvt_pk_bf16_f32 v52, v52, v53
    v_cvt_pk_bf16_f32 v53, v54, v55
    v_cvt_pk_bf16_f32 v54, v56, v57
    v_cvt_pk_bf16_f32 v55, v58, v59
    v_exp_f32 v60, v60
    v_exp_f32 v61, v61
    v_mfma_f32_32x32x16_bf16 v[84:99], v[36:39], v[52:55], v[84:99]
    buffer_load_dwordx4 v[212:215], v3, s[36:39], s51 offen offset:0
    v_exp_f32 v62, v62
    v_exp_f32 v63, v63
    v_exp_f32 v64, v64
    v_exp_f32 v65, v65
    v_exp_f32 v66, v66
    v_exp_f32 v67, v67
    v_cvt_pk_bf16_f32 v56, v60, v61
    v_cvt_pk_bf16_f32 v57, v62, v63
    v_cvt_pk_bf16_f32 v58, v64, v65
    v_cvt_pk_bf16_f32 v59, v66, v67
    v_exp_f32 v68, v68
    v_exp_f32 v69, v69
    v_mfma_f32_32x32x16_bf16 v[84:99], v[40:43], v[56:59], v[84:99]
    s_waitcnt lgkmcnt(0)
    ds_read_b128 v[32:35], v5 offset:12288
    v_exp_f32 v70, v70
    v_exp_f32 v71, v71
    v_mfma_f32_32x32x16_bf16 v[52:67], v[28:31], v[24:27], 0
    s_mov_b64 exec, s[54:55]
    ds_read_b128 v[36:39], v7 offset:10240
    ds_read_b128 v[40:43], v7 offset:10752
    s_mov_b64 exec, -1
    v_exp_f32 v72, v72
    v_exp_f32 v73, v73
    v_exp_f32 v74, v74
    v_exp_f32 v75, v75
    v_cvt_pk_bf16_f32 v68, v68, v69
    v_cvt_pk_bf16_f32 v69, v70, v71
    v_cvt_pk_bf16_f32 v70, v72, v73
    v_cvt_pk_bf16_f32 v71, v74, v75
    v_exp_f32 v76, v76
    v_exp_f32 v77, v77
    v_mfma_f32_32x32x16_bf16 v[84:99], v[44:47], v[68:71], v[84:99]
    buffer_load_dwordx4 v[216:219], v3, s[36:39], s51 offen offset:1024
    v_exp_f32 v78, v78
    v_exp_f32 v79, v79
    v_exp_f32 v80, v80
    v_exp_f32 v81, v81
    v_exp_f32 v82, v82
    v_exp_f32 v83, v83
    v_cvt_pk_bf16_f32 v72, v76, v77
    v_cvt_pk_bf16_f32 v73, v78, v79
    v_cvt_pk_bf16_f32 v74, v80, v81
    v_cvt_pk_bf16_f32 v75, v82, v83
    v_exp_f32 v52, v52
    v_exp_f32 v53, v53
    v_mfma_f32_32x32x16_bf16 v[84:99], v[48:51], v[72:75], v[84:99]
    s_waitcnt lgkmcnt(0)
    ds_read_b128 v[28:31], v5 offset:14336
    v_exp_f32 v54, v54
    v_exp_f32 v55, v55
    v_mfma_f32_32x32x16_bf16 v[68:83], v[32:35], v[24:27], 0
    s_mov_b64 exec, s[54:55]
    ds_read_b128 v[44:47], v7 offset:12288
    ds_read_b128 v[48:51], v7 offset:12800
    s_mov_b64 exec, -1
    v_exp_f32 v56, v56
    v_exp_f32 v57, v57
    v_exp_f32 v58, v58
    v_exp_f32 v59, v59
    v_cvt_pk_bf16_f32 v52, v52, v53
    v_cvt_pk_bf16_f32 v53, v54, v55
    v_cvt_pk_bf16_f32 v54, v56, v57
    v_cvt_pk_bf16_f32 v55, v58, v59
    v_exp_f32 v60, v60
    v_exp_f32 v61, v61
    v_mfma_f32_32x32x16_bf16 v[84:99], v[36:39], v[52:55], v[84:99]
    buffer_load_dwordx4 v[220:223], v3, s[36:39], s51 offen offset:2048
    v_exp_f32 v62, v62
    v_exp_f32 v63, v63
    v_exp_f32 v64, v64
    v_exp_f32 v65, v65
    v_exp_f32 v66, v66
    v_exp_f32 v67, v67
    v_cvt_pk_bf16_f32 v56, v60, v61
    v_cvt_pk_bf16_f32 v57, v62, v63
    v_cvt_pk_bf16_f32 v58, v64, v65
    v_cvt_pk_bf16_f32 v59, v66, v67
    v_exp_f32 v68, v68
    v_exp_f32 v69, v69
    v_mfma_f32_32x32x16_bf16 v[84:99], v[40:43], v[56:59], v[84:99]
    s_waitcnt lgkmcnt(0)
    ds_read_b128 v[32:35], v5 offset:16384
    v_exp_f32 v70, v70
    v_exp_f32 v71, v71
    v_mfma_f32_32x32x16_bf16 v[52:67], v[28:31], v[24:27], 0
    s_mov_b64 exec, s[54:55]
    ds_read_b128 v[36:39], v7 offset:14336
    ds_read_b128 v[40:43], v7 offset:14848
    s_mov_b64 exec, -1
    v_exp_f32 v72, v72
    v_exp_f32 v73, v73
    v_exp_f32 v74, v74
    v_exp_f32 v75, v75
    v_cvt_pk_bf16_f32 v68, v68, v69
    v_cvt_pk_bf16_f32 v69, v70, v71
    v_cvt_pk_bf16_f32 v70, v72, v73
    v_cvt_pk_bf16_f32 v71, v74, v75
    v_exp_f32 v76, v76
    v_exp_f32 v77, v77
    v_mfma_f32_32x32x16_bf16 v[84:99], v[44:47], v[68:71], v[84:99]
    buffer_load_dwordx4 v[224:227], v3, s[36:39], s51 offen offset:3072
    s_add_u32 s51, s51, 4096
    v_exp_f32 v78, v78
    v_exp_f32 v79, v79
    v_exp_f32 v80, v80
    v_exp_f32 v81, v81
    v_exp_f32 v82, v82
    v_exp_f32 v83, v83
    v_cvt_pk_bf16_f32 v72, v76, v77
    v_cvt_pk_bf16_f32 v73, v78, v79
    v_cvt_pk_bf16_f32 v74, v80, v81
    v_cvt_pk_bf16_f32 v75, v82, v83
    v_exp_f32 v52, v52
    v_exp_f32 v53, v53
    v_mfma_f32_32x32x16_bf16 v[84:99], v[48:51], v[72:75], v[84:99]
    s_waitcnt lgkmcnt(0)
    ds_read_b128 v[28:31], v5 offset:18432
    v_exp_f32 v54, v54
    v_exp_f32 v55, v55
    v_mfma_f32_32x32x16_bf16 v[68:83], v[32:35], v[24:27], 0
    s_mov_b64 exec, s[54:55]
    ds_read_b128 v[44:47], v7 offset:16384
    ds_read_b128 v[48:51], v7 offset:16896
    s_mov_b64 exec, -1
    v_exp_f32 v56, v56
    v_exp_f32 v57, v57
    v_exp_f32 v58, v58
    v_exp_f32 v59, v59
    v_cvt_pk_bf16_f32 v52, v52, v53
    v_cvt_pk_bf16_f32 v53, v54, v55
    v_cvt_pk_bf16_f32 v54, v56, v57
    v_cvt_pk_bf16_f32 v55, v58, v59
    v_exp_f32 v60, v60
    v_exp_f32 v61, v61
    v_mfma_f32_32x32x16_bf16 v[84:99], v[36:39], v[52:55], v[84:99]
    buffer_load_dwordx4 v[228:231], v3, s[36:39], s51 offen offset:0
    v_exp_f32 v62, v62
    v_exp_f32 v63, v63
    v_exp_f32 v64, v64
    v_exp_f32 v65, v65
    v_exp_f32 v66, v66
    v_exp_f32 v67, v67
    v_cvt_pk_bf16_f32 v56, v60, v61
    v_cvt_pk_bf16_f32 v57, v62, v63
    v_cvt_pk_bf16_f32 v58, v64, v65
    v_cvt_pk_bf16_f32 v59, v66, v67
    v_exp_f32 v68, v68
    v_exp_f32 v69, v69
    v_mfma_f32_32x32x16_bf16 v[84:99], v[40:43], v[56:59], v[84:99]
    s_waitcnt lgkmcnt(0)
    ds_read_b128 v[32:35], v5 offset:20480
    v_exp_f32 v70, v70
    v_exp_f32 v71, v71
    v_mfma_f32_32x32x16_bf16 v[52:67], v[28:31], v[24:27], 0
    s_mov_b64 exec, s[54:55]
    ds_read_b128 v[36:39], v7 offset:18432
    ds_read_b128 v[40:43], v7 offset:18944
    s_mov_b64 exec, -1
    v_exp_f32 v72, v72
    v_exp_f32 v73, v73
    v_exp_f32 v74, v74
    v_exp_f32 v75, v75
    v_cvt_pk_bf16_f32 v68, v68, v69
    v_cvt_pk_bf16_f32 v69, v70, v71
    v_cvt_pk_bf16_f32 v70, v72, v73
    v_cvt_pk_bf16_f32 v71, v74, v75
    v_exp_f32 v76, v76
    v_exp_f32 v77, v77
    v_mfma_f32_32x32x16_bf16 v[84:99], v[44:47], v[68:71], v[84:99]
    buffer_load_dwordx4 v[232:235], v3, s[36:39], s51 offen offset:1024
    v_exp_f32 v78, v78
    v_exp_f32 v79, v79
    v_exp_f32 v80, v80
    v_exp_f32 v81, v81
    v_exp_f32 v82, v82
    v_exp_f32 v83, v83
    v_cvt_pk_bf16_f32 v72, v76, v77
    v_cvt_pk_bf16_f32 v73, v78, v79
    v_cvt_pk_bf16_f32 v74, v80, v81
    v_cvt_pk_bf16_f32 v75, v82, v83
    v_exp_f32 v52, v52
    v_exp_f32 v53, v53
    v_mfma_f32_32x32x16_bf16 v[84:99], v[48:51], v[72:75], v[84:99]
    s_waitcnt lgkmcnt(0)
    ds_read_b128 v[28:31], v5 offset:22528
    v_exp_f32 v54, v54
    v_exp_f32 v55, v55
    v_mfma_f32_32x32x16_bf16 v[68:83], v[32:35], v[24:27], 0
    s_mov_b64 exec, s[54:55]
    ds_read_b128 v[44:47], v7 offset:20480
    ds_read_b128 v[48:51], v7 offset:20992
    s_mov_b64 exec, -1
    v_exp_f32 v56, v56
    v_exp_f32 v57, v57
    v_exp_f32 v58, v58
    v_exp_f32 v59, v59
    v_cvt_pk_bf16_f32 v52, v52, v53
    v_cvt_pk_bf16_f32 v53, v54, v55
    v_cvt_pk_bf16_f32 v54, v56, v57
    v_cvt_pk_bf16_f32 v55, v58, v59
    v_exp_f32 v60, v60
    v_exp_f32 v61, v61
    v_mfma_f32_32x32x16_bf16 v[84:99], v[36:39], v[52:55], v[84:99]
    buffer_load_dwordx4 v[236:239], v3, s[36:39], s51 offen offset:2048
    v_exp_f32 v62, v62
    v_exp_f32 v63, v63
    v_exp_f32 v64, v64
    v_exp_f32 v65, v65
    v_exp_f32 v66, v66
    v_exp_f32 v67, v67
    v_cvt_pk_bf16_f32 v56, v60, v61
    v_cvt_pk_bf16_f32 v57, v62, v63
    v_cvt_pk_bf16_f32 v58, v64, v65
    v_cvt_pk_bf16_f32 v59, v66, v67
    v_exp_f32 v68, v68
    v_exp_f32 v69, v69
    v_mfma_f32_32x32x16_bf16 v[84:99], v[40:43], v[56:59], v[84:99]
    s_waitcnt lgkmcnt(0)
    ds_read_b128 v[32:35], v5 offset:24576
    v_exp_f32 v70, v70
    v_exp_f32 v71, v71
    v_mfma_f32_32x32x16_bf16 v[52:67], v[28:31], v[24:27], 0
    s_mov_b64 exec, s[54:55]
    ds_read_b128 v[36:39], v7 offset:22528
    ds_read_b128 v[40:43], v7 offset:23040
    s_mov_b64 exec, -1
    v_exp_f32 v72, v72
    v_exp_f32 v73, v73
    v_exp_f32 v74, v74
    v_exp_f32 v75, v75
    v_cvt_pk_bf16_f32 v68, v68, v69
    v_cvt_pk_bf16_f32 v69, v70, v71
    v_cvt_pk_bf16_f32 v70, v72, v73
    v_cvt_pk_bf16_f32 v71, v74, v75
    v_exp_f32 v76, v76
    v_exp_f32 v77, v77
    v_mfma_f32_32x32x16_bf16 v[84:99], v[44:47], v[68:71], v[84:99]
    buffer_load_dwordx4 v[240:243], v3, s[36:39], s51 offen offset:3072
    s_add_u32 s51, s51, 4096
    v_exp_f32 v78, v78
    v_exp_f32 v79, v79
    v_exp_f32 v80, v80
    v_exp_f32 v81, v81
    v_exp_f32 v82, v82
    v_exp_f32 v83, v83
    v_cvt_pk_bf16_f32 v72, v76, v77
    v_cvt_pk_bf16_f32 v73, v78, v79
    v_cvt_pk_bf16_f32 v74, v80, v81
    v_cvt_pk_bf16_f32 v75, v82, v83
    v_exp_f32 v52, v52
    v_exp_f32 v53, v53
    v_mfma_f32_32x32x16_bf16 v[84:99], v[48:51], v[72:75], v[84:99]
    s_waitcnt lgkmcnt(0)
    ds_read_b128 v[28:31], v5 offset:26624
    v_exp_f32 v54, v54
    v_exp_f32 v55, v55
    v_mfma_f32_32x32x16_bf16 v[68:83], v[32:35], v[24:27], 0
    s_mov_b64 exec, s[54:55]
    ds_read_b128 v[44:47], v7 offset:24576
    ds_read_b128 v[48:51], v7 offset:25088
    s_mov_b64 exec, -1
    v_exp_f32 v56, v56
    v_exp_f32 v57, v57
    v_exp_f32 v58, v58
    v_exp_f32 v59, v59
    v_cvt_pk_bf16_f32 v52, v52, v53
    v_cvt_pk_bf16_f32 v53, v54, v55
    v_cvt_pk_bf16_f32 v54, v56, v57
    v_cvt_pk_bf16_f32 v55, v58, v59
    v_exp_f32 v60, v60
    v_exp_f32 v61, v61
    v_mfma_f32_32x32x16_bf16 v[84:99], v[36:39], v[52:55], v[84:99]
    buffer_load_dwordx4 v[244:247], v3, s[36:39], s51 offen offset:0
    v_exp_f32 v62, v62
    v_exp_f32 v63, v63
    v_exp_f32 v64, v64
    v_exp_f32 v65, v65
    v_exp_f32 v66, v66
    v_exp_f32 v67, v67
    v_cvt_pk_bf16_f32 v56, v60, v61
    v_cvt_pk_bf16_f32 v57, v62, v63
    v_cvt_pk_bf16_f32 v58, v64, v65
    v_cvt_pk_bf16_f32 v59, v66, v67
    v_exp_f32 v68, v68
    v_exp_f32 v69, v69
    v_mfma_f32_32x32x16_bf16 v[84:99], v[40:43], v[56:59], v[84:99]
    s_waitcnt lgkmcnt(0)
    ds_read_b128 v[32:35], v5 offset:28672
    v_exp_f32 v70, v70
    v_exp_f32 v71, v71
    v_mfma_f32_32x32x16_bf16 v[52:67], v[28:31], v[24:27], 0
    s_mov_b64 exec, s[54:55]
    ds_read_b128 v[36:39], v7 offset:26624
    ds_read_b128 v[40:43], v7 offset:27136
    s_mov_b64 exec, -1
    v_exp_f32 v72, v72
    v_exp_f32 v73, v73
    v_exp_f32 v74, v74
    v_exp_f32 v75, v75
    v_cvt_pk_bf16_f32 v68, v68, v69
    v_cvt_pk_bf16_f32 v69, v70, v71
    v_cvt_pk_bf16_f32 v70, v72, v73
    v_cvt_pk_bf16_f32 v71, v74, v75
    v_exp_f32 v76, v76
    v_exp_f32 v77, v77
    v_mfma_f32_32x32x16_bf16 v[84:99], v[44:47], v[68:71], v[84:99]
    buffer_load_dwordx4 v[248:251], v3, s[36:39], s51 offen offset:1024
    v_exp_f32 v78, v78
    v_exp_f32 v79, v79
    v_exp_f32 v80, v80
    v_exp_f32 v81, v81
    v_exp_f32 v82, v82
    v_exp_f32 v83, v83
    v_cvt_pk_bf16_f32 v72, v76, v77
    v_cvt_pk_bf16_f32 v73, v78, v79
    v_cvt_pk_bf16_f32 v74, v80, v81
    v_cvt_pk_bf16_f32 v75, v82, v83
    v_exp_f32 v52, v52
    v_exp_f32 v53, v53
    v_mfma_f32_32x32x16_bf16 v[84:99], v[48:51], v[72:75], v[84:99]
    s_waitcnt lgkmcnt(0)
    ds_read_b128 v[28:31], v5 offset:30720
    v_exp_f32 v54, v54
    v_exp_f32 v55, v55
    v_mfma_f32_32x32x16_bf16 v[68:83], v[32:35], v[24:27], 0
    s_mov_b64 exec, s[54:55]
    ds_read_b128 v[44:47], v7 offset:28672
    ds_read_b128 v[48:51], v7 offset:29184
    s_mov_b64 exec, -1
    v_exp_f32 v56, v56
    v_exp_f32 v57, v57
    v_exp_f32 v58, v58
    v_exp_f32 v59, v59
    v_cvt_pk_bf16_f32 v52, v52, v53
    v_cvt_pk_bf16_f32 v53, v54, v55
    v_cvt_pk_bf16_f32 v54, v56, v57
    v_cvt_pk_bf16_f32 v55, v58, v59
    v_exp_f32 v60, v60
    v_exp_f32 v61, v61
    v_mfma_f32_32x32x16_bf16 v[84:99], v[36:39], v[52:55], v[84:99]
    buffer_load_dwordx4 v[252:255], v3, s[36:39], s51 offen offset:2048
    v_exp_f32 v62, v62
    v_exp_f32 v63, v63
    v_exp_f32 v64, v64
    v_exp_f32 v65, v65
    v_exp_f32 v66, v66
    v_exp_f32 v67, v67
    v_cvt_pk_bf16_f32 v56, v60, v61
    v_cvt_pk_bf16_f32 v57, v62, v63
    v_cvt_pk_bf16_f32 v58, v64, v65
    v_cvt_pk_bf16_f32 v59, v66, v67
    v_exp_f32 v68, v68
    v_exp_f32 v69, v69
    v_mfma_f32_32x32x16_bf16 v[84:99], v[40:43], v[56:59], v[84:99]
    s_waitcnt lgkmcnt(0)
    ds_read_b128 v[32:35], v5 offset:32768
    v_exp_f32 v70, v70
    v_exp_f32 v71, v71
    v_mfma_f32_32x32x16_bf16 v[52:67], v[28:31], v[24:27], 0
    s_mov_b64 exec, s[54:55]
    ds_read_b128 v[36:39], v7 offset:30720
    ds_read_b128 v[40:43], v7 offset:31232
    s_mov_b64 exec, -1
    v_exp_f32 v72, v72
    v_exp_f32 v73, v73
    v_exp_f32 v74, v74
    v_exp_f32 v75, v75
    v_cvt_pk_bf16_f32 v68, v68, v69
    v_cvt_pk_bf16_f32 v69, v70, v71
    v_cvt_pk_bf16_f32 v70, v72, v73
    v_cvt_pk_bf16_f32 v71, v74, v75
    v_exp_f32 v76, v76
    v_exp_f32 v77, v77
    v_mfma_f32_32x32x16_bf16 v[84:99], v[44:47], v[68:71], v[84:99]
    v_exp_f32 v78, v78
    v_exp_f32 v79, v79
    v_exp_f32 v80, v80
    v_exp_f32 v81, v81
    v_exp_f32 v82, v82
    v_exp_f32 v83, v83
    v_cvt_pk_bf16_f32 v72, v76, v77
    v_cvt_pk_bf16_f32 v73, v78, v79
    v_cvt_pk_bf16_f32 v74, v80, v81
    v_cvt_pk_bf16_f32 v75, v82, v83
    v_exp_f32 v52, v52
    v_exp_f32 v53, v53
    v_mfma_f32_32x32x16_bf16 v[84:99], v[48:51], v[72:75], v[84:99]
    s_waitcnt lgkmcnt(0)
    ds_read_b128 v[28:31], v5 offset:34816
    v_exp_f32 v54, v54
    v_exp_f32 v55, v55
    v_mfma_f32_32x32x16_bf16 v[68:83], v[32:35], v[24:27], 0
    s_mov_b64 exec, s[54:55]
    ds_read_b128 v[44:47], v7 offset:32768
    ds_read_b128 v[48:51], v7 offset:33280
    s_mov_b64 exec, -1
    v_exp_f32 v56, v56
    v_exp_f32 v57, v57
    v_exp_f32 v58, v58
    v_exp_f32 v59, v59
    v_cvt_pk_bf16_f32 v52, v52, v53
    v_cvt_pk_bf16_f32 v53, v54, v55
    v_cvt_pk_bf16_f32 v54, v56, v57
    v_cvt_pk_bf16_f32 v55, v58, v59
    v_exp_f32 v60, v60
    v_exp_f32 v61, v61
    v_mfma_f32_32x32x16_bf16 v[84:99], v[36:39], v[52:55], v[84:99]
    v_exp_f32 v62, v62
    v_exp_f32 v63, v63
    v_exp_f32 v64, v64
    v_exp_f32 v65, v65
    v_exp_f32 v66, v66
    v_exp_f32 v67, v67
    v_cvt_pk_bf16_f32 v56, v60, v61
    v_cvt_pk_bf16_f32 v57, v62, v63
    v_cvt_pk_bf16_f32 v58, v64, v65
    v_cvt_pk_bf16_f32 v59, v66, v67
    v_exp_f32 v68, v68
    v_exp_f32 v69, v69
    v_mfma_f32_32x32x16_bf16 v[84:99], v[40:43], v[56:59], v[84:99]
    s_waitcnt lgkmcnt(0)
    ds_read_b128 v[32:35], v5 offset:36864
    v_exp_f32 v70, v70
    v_exp_f32 v71, v71
    v_mfma_f32_32x32x16_bf16 v[52:67], v[28:31], v[24:27], 0
    s_mov_b64 exec, s[54:55]
    ds_read_b128 v[36:39], v7 offset:34816
    ds_read_b128 v[40:43], v7 offset:35328
    s_mov_b64 exec, -1
    v_exp_f32 v72, v72
    v_exp_f32 v73, v73
    v_exp_f32 v74, v74
    v_exp_f32 v75, v75
    v_cvt_pk_bf16_f32 v68, v68, v69
    v_cvt_pk_bf16_f32 v69, v70, v71
    v_cvt_pk_bf16_f32 v70, v72, v73
    v_cvt_pk_bf16_f32 v71, v74, v75
    v_exp_f32 v76, v76
    v_exp_f32 v77, v77
    v_mfma_f32_32x32x16_bf16 v[84:99], v[44:47], v[68:71], v[84:99]
    v_exp_f32 v78, v78
    v_exp_f32 v79, v79
    v_exp_f32 v80, v80
    v_exp_f32 v81, v81
    v_exp_f32 v82, v82
    v_exp_f32 v83, v83
    v_cvt_pk_bf16_f32 v72, v76, v77
    v_cvt_pk_bf16_f32 v73, v78, v79
    v_cvt_pk_bf16_f32 v74, v80, v81
    v_cvt_pk_bf16_f32 v75, v82, v83
    v_exp_f32 v52, v52
    v_exp_f32 v53, v53
    v_mfma_f32_32x32x16_bf16 v[84:99], v[48:51], v[72:75], v[84:99]
    s_waitcnt lgkmcnt(0)
    ds_read_b128 v[28:31], v5 offset:38912
    v_exp_f32 v54, v54
    v_exp_f32 v55, v55
    v_mfma_f32_32x32x16_bf16 v[68:83], v[32:35], v[24:27], 0
    s_mov_b64 exec, s[54:55]
    ds_read_b128 v[44:47], v7 offset:36864
    ds_read_b128 v[48:51], v7 offset:37376
    s_mov_b64 exec, -1
    v_exp_f32 v56, v56
    v_exp_f32 v57, v57
    v_exp_f32 v58, v58
    v_exp_f32 v59, v59
    v_cvt_pk_bf16_f32 v52, v52, v53
    v_cvt_pk_bf16_f32 v53, v54, v55
    v_cvt_pk_bf16_f32 v54, v56, v57
    v_cvt_pk_bf16_f32 v55, v58, v59
    v_exp_f32 v60, v60
    v_exp_f32 v61, v61
    v_mfma_f32_32x32x16_bf16 v[84:99], v[36:39], v[52:55], v[84:99]
    v_exp_f32 v62, v62
    v_exp_f32 v63, v63
    v_exp_f32 v64, v64
    v_exp_f32 v65, v65
    v_exp_f32 v66, v66
    v_exp_f32 v67, v67
    v_cvt_pk_bf16_f32 v56, v60, v61
    v_cvt_pk_bf16_f32 v57, v62, v63
    v_cvt_pk_bf16_f32 v58, v64, v65
    v_cvt_pk_bf16_f32 v59, v66, v67
    v_exp_f32 v68, v68
    v_exp_f32 v69, v69
    v_mfma_f32_32x32x16_bf16 v[84:99], v[40:43], v[56:59], v[84:99]
    s_waitcnt lgkmcnt(0)
    ds_read_b128 v[32:35], v5 offset:40960
    v_exp_f32 v70, v70
    v_exp_f32 v71, v71
    v_mfma_f32_32x32x16_bf16 v[52:67], v[28:31], v[24:27], 0
    s_mov_b64 exec, s[54:55]
    ds_read_b128 v[36:39], v7 offset:38912
    ds_read_b128 v[40:43], v7 offset:39424
    s_mov_b64 exec, -1
    v_exp_f32 v72, v72
    v_exp_f32 v73, v73
    v_exp_f32 v74, v74
    v_exp_f32 v75, v75
    v_cvt_pk_bf16_f32 v68, v68, v69
    v_cvt_pk_bf16_f32 v69, v70, v71
    v_cvt_pk_bf16_f32 v70, v72, v73
    v_cvt_pk_bf16_f32 v71, v74, v75
    v_exp_f32 v76, v76
    v_exp_f32 v77, v77
    v_mfma_f32_32x32x16_bf16 v[84:99], v[44:47], v[68:71], v[84:99]
    v_exp_f32 v78, v78
    v_exp_f32 v79, v79
    v_exp_f32 v80, v80
    v_exp_f32 v81, v81
    v_exp_f32 v82, v82
    v_exp_f32 v83, v83
    v_cvt_pk_bf16_f32 v72, v76, v77
    v_cvt_pk_bf16_f32 v73, v78, v79
    v_cvt_pk_bf16_f32 v74, v80, v81
    v_cvt_pk_bf16_f32 v75, v82, v83
    v_exp_f32 v52, v52
    v_exp_f32 v53, v53
    v_mfma_f32_32x32x16_bf16 v[84:99], v[48:51], v[72:75], v[84:99]
    s_waitcnt lgkmcnt(0)
    ds_read_b128 v[28:31], v5 offset:43008
    v_exp_f32 v54, v54
    v_exp_f32 v55, v55
    v_mfma_f32_32x32x16_bf16 v[68:83], v[32:35], v[24:27], 0
    s_mov_b64 exec, s[54:55]
    ds_read_b128 v[44:47], v7 offset:40960
    ds_read_b128 v[48:51], v7 offset:41472
    s_mov_b64 exec, -1
    v_exp_f32 v56, v56
    v_exp_f32 v57, v57
    v_exp_f32 v58, v58
    v_exp_f32 v59, v59
    v_cvt_pk_bf16_f32 v52, v52, v53
    v_cvt_pk_bf16_f32 v53, v54, v55
    v_cvt_pk_bf16_f32 v54, v56, v57
    v_cvt_pk_bf16_f32 v55, v58, v59
    v_exp_f32 v60, v60
    v_exp_f32 v61, v61
    v_mfma_f32_32x32x16_bf16 v[84:99], v[36:39], v[52:55], v[84:99]
    v_exp_f32 v62, v62
    v_exp_f32 v63, v63
    v_exp_f32 v64, v64
    v_exp_f32 v65, v65
    v_exp_f32 v66, v66
    v_exp_f32 v67, v67
    v_cvt_pk_bf16_f32 v56, v60, v61
    v_cvt_pk_bf16_f32 v57, v62, v63
    v_cvt_pk_bf16_f32 v58, v64, v65
    v_cvt_pk_bf16_f32 v59, v66, v67
    v_exp_f32 v68, v68
    v_exp_f32 v69, v69
    v_mfma_f32_32x32x16_bf16 v[84:99], v[40:43], v[56:59], v[84:99]
    s_waitcnt lgkmcnt(0)
    ds_read_b128 v[32:35], v5 offset:45056
    v_exp_f32 v70, v70
    v_exp_f32 v71, v71
    v_mfma_f32_32x32x16_bf16 v[52:67], v[28:31], v[24:27], 0
    s_mov_b64 exec, s[54:55]
    ds_read_b128 v[36:39], v7 offset:43008
    ds_read_b128 v[40:43], v7 offset:43520
    s_mov_b64 exec, -1
    v_exp_f32 v72, v72
    v_exp_f32 v73, v73
    v_exp_f32 v74, v74
    v_exp_f32 v75, v75
    v_cvt_pk_bf16_f32 v68, v68, v69
    v_cvt_pk_bf16_f32 v69, v70, v71
    v_cvt_pk_bf16_f32 v70, v72, v73
    v_cvt_pk_bf16_f32 v71, v74, v75
    v_exp_f32 v76, v76
    v_exp_f32 v77, v77
    v_mfma_f32_32x32x16_bf16 v[84:99], v[44:47], v[68:71], v[84:99]
    v_exp_f32 v78, v78
    v_exp_f32 v79, v79
    v_exp_f32 v80, v80
    v_exp_f32 v81, v81
    v_exp_f32 v82, v82
    v_exp_f32 v83, v83
    v_cvt_pk_bf16_f32 v72, v76, v77
    v_cvt_pk_bf16_f32 v73, v78, v79
    v_cvt_pk_bf16_f32 v74, v80, v81
    v_cvt_pk_bf16_f32 v75, v82, v83
    v_exp_f32 v52, v52
    v_exp_f32 v53, v53
    v_mfma_f32_32x32x16_bf16 v[84:99], v[48:51], v[72:75], v[84:99]
    s_waitcnt lgkmcnt(0)
    ds_read_b128 v[28:31], v5 offset:47104
    v_exp_f32 v54, v54
    v_exp_f32 v55, v55
    v_mfma_f32_32x32x16_bf16 v[68:83], v[32:35], v[24:27], 0
    s_mov_b64 exec, s[54:55]
    ds_read_b128 v[44:47], v7 offset:45056
    ds_read_b128 v[48:51], v7 offset:45568
    s_mov_b64 exec, -1
    v_exp_f32 v56, v56
    v_exp_f32 v57, v57
    v_exp_f32 v58, v58
    v_exp_f32 v59, v59
    v_cvt_pk_bf16_f32 v52, v52, v53
    v_cvt_pk_bf16_f32 v53, v54, v55
    v_cvt_pk_bf16_f32 v54, v56, v57
    v_cvt_pk_bf16_f32 v55, v58, v59
    v_exp_f32 v60, v60
    v_exp_f32 v61, v61
    v_mfma_f32_32x32x16_bf16 v[84:99], v[36:39], v[52:55], v[84:99]
    v_exp_f32 v62, v62
    v_exp_f32 v63, v63
    v_exp_f32 v64, v64
    v_exp_f32 v65, v65
    v_exp_f32 v66, v66
    v_exp_f32 v67, v67
    v_cvt_pk_bf16_f32 v56, v60, v61
    v_cvt_pk_bf16_f32 v57, v62, v63
    v_cvt_pk_bf16_f32 v58, v64, v65
    v_cvt_pk_bf16_f32 v59, v66, v67
    v_exp_f32 v68, v68
    v_exp_f32 v69, v69
    v_mfma_f32_32x32x16_bf16 v[84:99], v[40:43], v[56:59], v[84:99]
    s_waitcnt lgkmcnt(0)
    ds_read_b128 v[32:35], v5 offset:49152
    v_exp_f32 v70, v70
    v_exp_f32 v71, v71
    v_mfma_f32_32x32x16_bf16 v[52:67], v[28:31], v[24:27], 0
    s_mov_b64 exec, s[54:55]
    ds_read_b128 v[36:39], v7 offset:47104
    ds_read_b128 v[40:43], v7 offset:47616
    s_mov_b64 exec, -1
    v_exp_f32 v72, v72
    v_exp_f32 v73, v73
    v_exp_f32 v74, v74
    v_exp_f32 v75, v75
    v_cvt_pk_bf16_f32 v68, v68, v69
    v_cvt_pk_bf16_f32 v69, v70, v71
    v_cvt_pk_bf16_f32 v70, v72, v73
    v_cvt_pk_bf16_f32 v71, v74, v75
    v_exp_f32 v76, v76
    v_exp_f32 v77, v77
    v_mfma_f32_32x32x16_bf16 v[84:99], v[44:47], v[68:71], v[84:99]
    v_exp_f32 v78, v78
    v_exp_f32 v79, v79
    v_exp_f32 v80, v80
    v_exp_f32 v81, v81
    v_exp_f32 v82, v82
    v_exp_f32 v83, v83
    v_cvt_pk_bf16_f32 v72, v76, v77
    v_cvt_pk_bf16_f32 v73, v78, v79
    v_cvt_pk_bf16_f32 v74, v80, v81
    v_cvt_pk_bf16_f32 v75, v82, v83
    v_exp_f32 v52, v52
    v_exp_f32 v53, v53
    v_mfma_f32_32x32x16_bf16 v[84:99], v[48:51], v[72:75], v[84:99]
    s_waitcnt lgkmcnt(0)
    v_exp_f32 v54, v54
    v_exp_f32 v55, v55
    v_mfma_f32_32x32x16_bf16 v[68:83], v[32:35], v[24:27], 0
    s_mov_b64 exec, s[54:55]
    ds_read_b128 v[44:47], v7 offset:49152
    ds_read_b128 v[48:51], v7 offset:49664
    s_mov_b64 exec, -1
    v_exp_f32 v56, v56
    v_exp_f32 v57, v57
    v_exp_f32 v58, v58
    v_exp_f32 v59, v59
    v_cvt_pk_bf16_f32 v52, v52, v53
    v_cvt_pk_bf16_f32 v53, v54, v55
    v_cvt_pk_bf16_f32 v54, v56, v57
    v_cvt_pk_bf16_f32 v55, v58, v59
    v_exp_f32 v60, v60
    v_exp_f32 v61, v61
    v_mfma_f32_32x32x16_bf16 v[84:99], v[36:39], v[52:55], v[84:99]
    v_exp_f32 v62, v62
    v_exp_f32 v63, v63
    v_exp_f32 v64, v64
    v_exp_f32 v65, v65
    v_exp_f32 v66, v66
    v_exp_f32 v67, v67
    v_cvt_pk_bf16_f32 v56, v60, v61
    v_cvt_pk_bf16_f32 v57, v62, v63
    v_cvt_pk_bf16_f32 v58, v64, v65
    v_cvt_pk_bf16_f32 v59, v66, v67
    v_exp_f32 v68, v68
    v_exp_f32 v69, v69
    v_mfma_f32_32x32x16_bf16 v[84:99], v[40:43], v[56:59], v[84:99]
    s_waitcnt lgkmcnt(0)
    v_exp_f32 v70, v70
    v_exp_f32 v71, v71
    v_exp_f32 v72, v72
    v_exp_f32 v73, v73
    v_exp_f32 v74, v74
    v_exp_f32 v75, v75
    v_cvt_pk_bf16_f32 v68, v68, v69
    v_cvt_pk_bf16_f32 v69, v70, v71
    v_cvt_pk_bf16_f32 v70, v72, v73
    v_cvt_pk_bf16_f32 v71, v74, v75
    v_exp_f32 v76, v76
    v_exp_f32 v77, v77
    v_mfma_f32_32x32x16_bf16 v[84:99], v[44:47], v[68:71], v[84:99]
    v_exp_f32 v78, v78
    v_exp_f32 v79, v79
    v_exp_f32 v80, v80
    v_exp_f32 v81, v81
    v_exp_f32 v82, v82
    v_exp_f32 v83, v83
    v_cvt_pk_bf16_f32 v72, v76, v77
    v_cvt_pk_bf16_f32 v73, v78, v79
    v_cvt_pk_bf16_f32 v74, v80, v81
    v_cvt_pk_bf16_f32 v75, v82, v83
    s_nop 1
    v_mfma_f32_32x32x16_bf16 v[84:99], v[48:51], v[72:75], v[84:99]
    s_branch B_OEPI
B_SLOW:
    s_barrier
    s_add_u32 s46, s44, 0
    s_and_b32 s46, s46, 63
    s_lshl_b32 s46, s46, 11
    s_add_u32 s47, s45, 0
    s_mov_b32 m0, s47
    s_nop 0
    buffer_load_dwordx4 v3, s[36:39], s46 offen lds
    buffer_load_dwordx4 v3, s[36:39], s46 offen offset:1024 lds
    s_add_u32 s46, s44, 8
    s_and_b32 s46, s46, 63
    s_lshl_b32 s46, s46, 11
    s_add_u32 s47, s45, 16384
    s_mov_b32 m0, s47
    s_nop 0
    buffer_load_dwordx4 v3, s[36:39], s46 offen lds
    buffer_load_dwordx4 v3, s[36:39], s46 offen offset:1024 lds
    s_add_u32 s46, s44, 16
    s_and_b32 s46, s46, 63
    s_lshl_b32 s46, s46, 11
    s_add_u32 s47, s45, 32768
    s_mov_b32 m0, s47
    s_nop 0
    buffer_load_dwordx4 v3, s[36:39], s46 offen lds
    buffer_load_dwordx4 v3, s[36:39], s46 offen offset:1024 lds
    s_add_u32 s46, s44, 24
    s_and_b32 s46, s46, 63
    s_lshl_b32 s46, s46, 11
    s_add_u32 s47, s45, 49152
    s_mov_b32 m0, s47
    s_nop 0
    buffer_load_dwordx4 v3, s[36:39], s46 offen lds
    buffer_load_dwordx4 v3, s[36:39], s46 offen offset:1024 lds
    s_add_u32 s46, s44, 32
    s_and_b32 s46, s46, 63
    s_lshl_b32 s46, s46, 11
    s_add_u32 s47, s45, 65536
    s_mov_b32 m0, s47
    s_nop 0
    buffer_load_dwordx4 v3, s[36:39], s46 offen lds
    buffer_load_dwordx4 v3, s[36:39], s46 offen offset:1024 lds
    s_add_u32 s46, s44, 40
    s_and_b32 s46, s46, 63
    s_lshl_b32 s46, s46, 11
    s_add_u32 s47, s45, 81920
    s_mov_b32 m0, s47
    s_nop 0
    buffer_load_dwordx4 v3, s[36:39], s46 offen lds
    buffer_load_dwordx4 v3, s[36:39], s46 offen offset:1024 lds
    s_add_u32 s46, s44, 48
    s_and_b32 s46, s46, 63
    s_lshl_b32 s46, s46, 11
    s_add_u32 s47, s45, 98304
    s_mov_b32 m0, s47
    s_nop 0
    buffer_load_dwordx4 v3, s[36:39], s46 offen lds
    buffer_load_dwordx4 v3, s[36:39], s46 offen offset:1024 lds
    s_cmp_lg_u32 s3, 0
    s_cbranch_scc1 SKD_6
    s_add_u32 s46, s44, 56
    s_and_b32 s46, s46, 63
    s_lshl_b32 s46, s46, 11
    s_add_u32 s47, s45, 114688
    s_mov_b32 m0, s47
    s_nop 0
    buffer_load_dwordx4 v3, s[36:39], s46 offen lds
    buffer_load_dwordx4 v3, s[36:39], s46 offen offset:1024 lds
SKD_6:
    s_waitcnt vmcnt(0)
    s_barrier
    v_mov_b32 v8, v4
    v_mov_b32 v10, 0xff800000
    s_mov_b32 s46, 0
B_S1:
    ds_read_b128 v[28:31], v8
    v_add_u32 v8, 2048, v8
    s_waitcnt lgkmcnt(0)
    v_mfma_f32_32x32x16_bf16 v[52:67], v[28:31], v[24:27], 0
    s_nop 11
    v_max3_f32 v10, v10, v52, v53
    v_max3_f32 v10, v10, v54, v55
    v_max3_f32 v10, v10, v56, v57
    v_max3_f32 v10, v10, v58, v59
    v_max3_f32 v10, v10, v60, v61
    v_max3_f32 v10, v10, v62, v63
    v_max3_f32 v10, v10, v64, v65
    v_max3_f32 v10, v10, v66, v67
    s_add_u32 s46, s46, 1
    s_cmp_lt_u32 s46, 64
    s_nop 11
    s_cbranch_scc1 B_S1
    v_mov_b32 v11, v10
    s_nop 1
    v_permlane32_swap_b32 v10, v11
    v_max_f32 v10, v10, v11
    v_sub_f32 v100, 0, v10
    v_mov_b32 v84, 0
    v_sub_f32 v101, 0, v10
    v_mov_b32 v85, 0
    v_sub_f32 v102, 0, v10
    v_mov_b32 v86, 0
    v_sub_f32 v103, 0, v10
    v_mov_b32 v87, 0
    v_sub_f32 v104, 0, v10
    v_mov_b32 v88, 0
    v_sub_f32 v105, 0, v10
    v_mov_b32 v89, 0
    v_sub_f32 v106, 0, v10
    v_mov_b32 v90, 0
    v_sub_f32 v107, 0, v10
    v_mov_b32 v91, 0
    v_sub_f32 v108, 0, v10
    v_mov_b32 v92, 0
    v_sub_f32 v109, 0, v10
    v_mov_b32 v93, 0
    v_sub_f32 v110, 0, v10
    v_mov_b32 v94, 0
    v_sub_f32 v111, 0, v10
    v_mov_b32 v95, 0
    v_sub_f32 v112, 0, v10
    v_mov_b32 v96, 0
    v_sub_f32 v113, 0, v10
    v_mov_b32 v97, 0
    v_sub_f32 v114, 0, v10
    v_mov_b32 v98, 0
    v_sub_f32 v115, 0, v10
    v_mov_b32 v99, 0
    v_mov_b32 v8, v4
    v_mov_b32 v9, v6
    s_mov_b32 s46, 0
B_S2:
    ds_read_b128 v[28:31], v8
    s_mov_b64 exec, s[54:55]
    ds_read_b128 v[36:39], v9
    ds_read_b128 v[40:43], v9 offset:512
    s_mov_b64 exec, -1
    v_add_u32 v8, 2048, v8
    v_add_u32 v9, 2048, v9
    s_waitcnt lgkmcnt(0)
    v_mfma_f32_32x32x16_bf16 v[52:67], v[28:31], v[24:27], v[100:115]
    s_nop 11
    v_exp_f32 v52, v52
    v_exp_f32 v53, v53
    v_exp_f32 v54, v54
    v_exp_f32 v55, v55
    v_exp_f32 v56, v56
    v_exp_f32 v57, v57
    v_exp_f32 v58, v58
    v_exp_f32 v59, v59
    v_exp_f32 v60, v60
    v_exp_f32 v61, v61
    v_exp_f32 v62, v62
    v_exp_f32 v63, v63
    v_exp_f32 v64, v64
    v_exp_f32 v65, v65
    v_exp_f32 v66, v66
    v_exp_f32 v67, v67
    v_cvt_pk_bf16_f32 v52, v52, v53
    v_cvt_pk_bf16_f32 v53, v54, v55
    v_cvt_pk_bf16_f32 v54, v56, v57
    v_cvt_pk_bf16_f32 v55, v58, v59
    v_cvt_pk_bf16_f32 v56, v60, v61
    v_cvt_pk_bf16_f32 v57, v62, v63
    v_cvt_pk_bf16_f32 v58, v64, v65
    v_cvt_pk_bf16_f32 v59, v66, v67
    v_mfma_f32_32x32x16_bf16 v[84:99], v[36:39], v[52:55], v[84:99]
    s_nop 0
    v_mfma_f32_32x32x16_bf16 v[84:99], v[40:43], v[56:59], v[84:99]
    s_add_u32 s46, s46, 1
    s_cmp_lt_u32 s46, 64
    s_nop 11
    s_cbranch_scc1 B_S2
    s_mov_b32 s69, 0
    v_and_b32 v9, 3, v1
    v_lshlrev_b32 v9, 6, v9
    s_mov_b64 exec, 15
B_PW2:
    buffer_load_dword v8, v9, s[24:27], 0 offen offset:32 sc1
    s_add_u32 s69, s69, 1
    s_waitcnt vmcnt(0)
    v_cmp_eq_u32 vcc, 64, v8
    s_nop 0
    s_cmp_eq_u64 vcc, 15
    s_cbranch_scc1 B_PW2_D
    s_cmp_lt_u32 s69, 40000
    s_nop 0
    s_cbranch_scc1 B_PW2
B_PW2_D:
    s_mov_b64 exec, -1
    buffer_load_dwordx4 v[100:103], v3, s[36:39], s50 offen offset:0
    buffer_load_dwordx4 v[104:107], v3, s[36:39], s50 offen offset:1024
    buffer_load_dwordx4 v[108:111], v3, s[36:39], s50 offen offset:2048
    buffer_load_dwordx4 v[112:115], v3, s[36:39], s50 offen offset:3072
    s_add_u32 s50, s50, 4096
    buffer_load_dwordx4 v[116:119], v3, s[36:39], s50 offen offset:0
    buffer_load_dwordx4 v[120:123], v3, s[36:39], s50 offen offset:1024
    buffer_load_dwordx4 v[124:127], v3, s[36:39], s50 offen offset:2048
    buffer_load_dwordx4 v[128:131], v3, s[36:39], s50 offen offset:3072
    s_add_u32 s50, s50, 4096
    buffer_load_dwordx4 v[132:135], v3, s[36:39], s50 offen offset:0
    buffer_load_dwordx4 v[136:139], v3, s[36:39], s50 offen offset:1024
    buffer_load_dwordx4 v[140:143], v3, s[36:39], s50 offen offset:2048
    buffer_load_dwordx4 v[144:147], v3, s[36:39], s50 offen offset:3072
    s_add_u32 s50, s50, 4096
    buffer_load_dwordx4 v[148:151], v3, s[36:39], s50 offen offset:0
    buffer_load_dwordx4 v[152:155], v3, s[36:39], s50 offen offset:1024
    buffer_load_dwordx4 v[156:159], v3, s[36:39], s50 offen offset:2048
    buffer_load_dwordx4 v[160:163], v3, s[36:39], s50 offen offset:3072
    s_add_u32 s50, s50, 4096
    buffer_load_dwordx4 v[164:167], v3, s[36:39], s51 offen offset:0
    buffer_load_dwordx4 v[168:171], v3, s[36:39], s51 offen offset:1024
    buffer_load_dwordx4 v[172:175], v3, s[36:39], s51 offen offset:2048
    buffer_load_dwordx4 v[176:179], v3, s[36:39], s51 offen offset:3072
    s_add_u32 s51, s51, 4096
    buffer_load_dwordx4 v[180:183], v3, s[36:39], s51 offen offset:0
    buffer_load_dwordx4 v[184:187], v3, s[36:39], s51 offen offset:1024
    buffer_load_dwordx4 v[188:191], v3, s[36:39], s51 offen offset:2048
    buffer_load_dwordx4 v[192:195], v3, s[36:39], s51 offen offset:3072
    s_add_u32 s51, s51, 4096
    buffer_load_dwordx4 v[196:199], v3, s[36:39], s51 offen offset:0
    buffer_load_dwordx4 v[200:203], v3, s[36:39], s51 offen offset:1024
    buffer_load_dwordx4 v[204:207], v3, s[36:39], s51 offen offset:2048
    buffer_load_dwordx4 v[208:211], v3, s[36:39], s51 offen offset:3072
    s_add_u32 s51, s51, 4096
    buffer_load_dwordx4 v[212:215], v3, s[36:39], s51 offen offset:0
    buffer_load_dwordx4 v[216:219], v3, s[36:39], s51 offen offset:1024
    buffer_load_dwordx4 v[220:223], v3, s[36:39], s51 offen offset:2048
    buffer_load_dwordx4 v[224:227], v3, s[36:39], s51 offen offset:3072
    s_add_u32 s51, s51, 4096
    buffer_load_dwordx4 v[228:231], v3, s[36:39], s51 offen offset:0
    buffer_load_dwordx4 v[232:235], v3, s[36:39], s51 offen offset:1024
    buffer_load_dwordx4 v[236:239], v3, s[36:39], s51 offen offset:2048
    buffer_load_dwordx4 v[240:243], v3, s[36:39], s51 offen offset:3072
    s_add_u32 s51, s51, 4096
    buffer_load_dwordx4 v[244:247], v3, s[36:39], s51 offen offset:0
    buffer_load_dwordx4 v[248:251], v3, s[36:39], s51 offen offset:1024
    buffer_load_dwordx4 v[252:255], v3, s[36:39], s51 offen offset:2048
B_OEPI:
    s_nop 10
    v_rcp_f32 v8, v92
    s_nop 0
    v_mul_f32 v84, v84, v8
    v_mul_f32 v85, v85, v8
    v_mul_f32 v86, v86, v8
    v_mul_f32 v87, v87, v8
    v_mul_f32 v88, v88, v8
    v_mul_f32 v89, v89, v8
    v_mul_f32 v90, v90, v8
    v_mul_f32 v91, v91, v8
    v_cvt_pk_bf16_f32 v12, v84, v85
    v_cvt_pk_bf16_f32 v13, v86, v87
    v_cvt_pk_bf16_f32 v14, v88, v89
    v_cvt_pk_bf16_f32 v15, v90, v91
    s_lshl_b32 s46, s41, 2
    s_and_b32 s47, s3, 1
    s_lshl_b32 s47, s47, 1
    s_add_u32 s46, s46, s47
    s_lshr_b32 s47, s3, 2
    s_add_u32 s46, s46, s47
    s_lshl_b32 s46, s46, 10
    s_bfe_u32 s47, s3, 0x10001
    s_lshl_b32 s47, s47, 15
    s_add_u32 s46, s46, s47
    s_lshl_b32 s52, s40, 16
    s_add_u32 s46, s46, s52
    s_add_u32 s46, s46, 1048576
    s_waitcnt vmcnt(0)
    s_cmp_eq_u32 s62, 0
    s_cbranch_scc1 HS_7
    buffer_store_dwordx4 v[12:15], v3, s[36:39], s46 offen
    buffer_load_dwordx4 v[84:87], v3, s[36:39], s46 offen sc1
    s_branch HD_8
HS_7:
    buffer_store_dwordx4 v[12:15], v3, s[36:39], s46 offen sc1
HD_8:
    buffer_load_dwordx4 v[28:31], v3, s[36:39], s51 offen offset:3072
    s_add_u32 s51, s51, 4096
    buffer_load_dwordx4 v[32:35], v3, s[36:39], s51 offen offset:0
    buffer_load_dwordx4 v[36:39], v3, s[36:39], s51 offen offset:1024
    buffer_load_dwordx4 v[40:43], v3, s[36:39], s51 offen offset:2048
    buffer_load_dwordx4 v[44:47], v3, s[36:39], s51 offen offset:3072
    s_add_u32 s51, s51, 4096
    buffer_load_dwordx4 v[48:51], v3, s[36:39], s51 offen offset:0
    buffer_load_dwordx4 v[52:55], v3, s[36:39], s51 offen offset:1024
    buffer_load_dwordx4 v[56:59], v3, s[36:39], s51 offen offset:2048
    buffer_load_dwordx4 v[60:63], v3, s[36:39], s51 offen offset:3072
    s_add_u32 s51, s51, 4096
    v_mov_b32 v64, 0x3f803f80
    v_mov_b32 v65, 0x3f803f80
    v_mov_b32 v66, 0x3f803f80
    v_mov_b32 v67, 0x3f803f80
    s_nop 1
    v_mfma_f32_32x32x16_bf16 v[68:83], v[164:167], v[64:67], 0
    v_mfma_f32_32x32x16_bf16 v[68:83], v[168:171], v[64:67], v[68:83]
    v_mfma_f32_32x32x16_bf16 v[68:83], v[172:175], v[64:67], v[68:83]
    v_mfma_f32_32x32x16_bf16 v[68:83], v[176:179], v[64:67], v[68:83]
    v_mfma_f32_32x32x16_bf16 v[68:83], v[180:183], v[64:67], v[68:83]
    v_mfma_f32_32x32x16_bf16 v[68:83], v[184:187], v[64:67], v[68:83]
    v_mfma_f32_32x32x16_bf16 v[68:83], v[188:191], v[64:67], v[68:83]
    v_mfma_f32_32x32x16_bf16 v[68:83], v[192:195], v[64:67], v[68:83]
    v_mfma_f32_32x32x16_bf16 v[68:83], v[196:199], v[64:67], v[68:83]
    v_mfma_f32_32x32x16_bf16 v[68:83], v[200:203], v[64:67], v[68:83]
    v_mfma_f32_32x32x16_bf16 v[68:83], v[204:207], v[64:67], v[68:83]
    v_mfma_f32_32x32x16_bf16 v[68:83], v[208:211], v[64:67], v[68:83]
    v_mfma_f32_32x32x16_bf16 v[68:83], v[212:215], v[64:67], v[68:83]
    v_mfma_f32_32x32x16_bf16 v[68:83], v[216:219], v[64:67], v[68:83]
    v_mfma_f32_32x32x16_bf16 v[68:83], v[220:223], v[64:67], v[68:83]
    v_mfma_f32_32x32x16_bf16 v[68:83], v[224:227], v[64:67], v[68:83]
    v_mfma_f32_32x32x16_bf16 v[68:83], v[228:231], v[64:67], v[68:83]
    v_mfma_f32_32x32x16_bf16 v[68:83], v[232:235], v[64:67], v[68:83]
    v_mfma_f32_32x32x16_bf16 v[68:83], v[236:239], v[64:67], v[68:83]
    v_mfma_f32_32x32x16_bf16 v[68:83], v[240:243], v[64:67], v[68:83]
    s_waitcnt vmcnt(9)
    s_lshl_b32 s46, s68, 7
    s_lshl_b32 s47, s3, 2
    s_add_u32 s46, s46, s47
    s_add_u32 s46, s46, 139264
    v_mov_b32 v8, 0
    v_mov_b32 v9, 1
    s_mov_b64 exec, 1
    s_cmp_eq_u32 s62, 0
    s_cbranch_scc1 FS_9
    buffer_store_dword v9, v8, s[36:39], s46 offen
    s_branch FD_10
FS_9:
    buffer_store_dword v9, v8, s[36:39], s46 offen sc1
FD_10:
    s_mov_b64 exec, -1
    v_mfma_f32_32x32x16_bf16 v[68:83], v[244:247], v[64:67], v[68:83]
    v_mfma_f32_32x32x16_bf16 v[68:83], v[248:251], v[64:67], v[68:83]
    v_mfma_f32_32x32x16_bf16 v[68:83], v[252:255], v[64:67], v[68:83]
    s_waitcnt vmcnt(1)
    v_mfma_f32_32x32x16_bf16 v[68:83], v[28:31], v[64:67], v[68:83]
    v_mfma_f32_32x32x16_bf16 v[68:83], v[32:35], v[64:67], v[68:83]
    v_mfma_f32_32x32x16_bf16 v[68:83], v[36:39], v[64:67], v[68:83]
    v_mfma_f32_32x32x16_bf16 v[68:83], v[40:43], v[64:67], v[68:83]
    v_mfma_f32_32x32x16_bf16 v[68:83], v[44:47], v[64:67], v[68:83]
    v_mfma_f32_32x32x16_bf16 v[68:83], v[48:51], v[64:67], v[68:83]
    v_mfma_f32_32x32x16_bf16 v[68:83], v[52:55], v[64:67], v[68:83]
    v_mfma_f32_32x32x16_bf16 v[68:83], v[56:59], v[64:67], v[68:83]
    v_mfma_f32_32x32x16_bf16 v[68:83], v[60:63], v[64:67], v[68:83]
    s_barrier
    v_and_b32 v10, 7, v1
    v_lshlrev_b32 v10, 2, v10
    s_lshl_b32 s48, s40, 3
    s_add_u32 s48, s48, s3
    s_lshl_b32 s48, s48, 7
    s_add_u32 s48, s48, 139264
    s_mov_b32 s69, 0
B_PO:
    buffer_load_dword v8, v10, s[36:39], s48 offen sc1
    s_add_u32 s69, s69, 1
    s_waitcnt vmcnt(0)
    v_cmp_eq_u32 vcc, 1, v8
    s_nop 0
    s_cmp_eq_u64 vcc, -1
    s_cbranch_scc1 B_PO_D
    s_cmp_lt_u32 s69, 40000
    s_nop 0
    s_cbranch_scc1 B_PO
B_PO_D:
    s_lshl_b32 s46, s3, 12
    s_add_u32 s47, s46, s52
    s_add_u32 s47, s47, 1048576
    s_mov_b32 m0, s46
    s_nop 0
    buffer_load_dwordx4 v3, s[36:39], s47 offen offset:0 lds
    buffer_load_dwordx4 v3, s[36:39], s47 offen offset:1024 lds
    buffer_load_dwordx4 v3, s[36:39], s47 offen offset:2048 lds
    buffer_load_dwordx4 v3, s[36:39], s47 offen offset:3072 lds
    s_add_u32 s46, s46, 32768
    s_add_u32 s47, s47, 32768
    s_mov_b32 m0, s46
    s_nop 0
    buffer_load_dwordx4 v3, s[36:39], s47 offen offset:0 lds
    buffer_load_dwordx4 v3, s[36:39], s47 offen offset:1024 lds
    buffer_load_dwordx4 v3, s[36:39], s47 offen offset:2048 lds
    buffer_load_dwordx4 v3, s[36:39], s47 offen offset:3072 lds
    s_mul_i32 s46, s41, 112
    s_mul_i32 s47, s3, 14
    s_add_u32 s46, s46, s47
    s_lshl_b32 s46, s46, 11
    s_add_u32 s56, s46, 6291456
    s_add_u32 s47, s3, 5
    s_and_b32 s47, s47, 7
    s_mul_i32 s47, s47, 10240
    s_add_u32 s47, s47, 65536
    s_mov_b32 s46, s56
    s_mov_b32 m0, s47
    s_add_u32 s47, s47, 4096
    buffer_load_dwordx4 v3, s[36:39], s46 offen offset:0 lds
    buffer_load_dwordx4 v3, s[36:39], s46 offen offset:1024 lds
    buffer_load_dwordx4 v3, s[36:39], s46 offen offset:2048 lds
    buffer_load_dwordx4 v3, s[36:39], s46 offen offset:3072 lds
    s_add_u32 s46, s46, 4096
    s_mov_b32 m0, s47
    s_add_u32 s47, s47, 4096
    buffer_load_dwordx4 v3, s[36:39], s46 offen offset:0 lds
    buffer_load_dwordx4 v3, s[36:39], s46 offen offset:1024 lds
    buffer_load_dwordx4 v3, s[36:39], s46 offen offset:2048 lds
    buffer_load_dwordx4 v3, s[36:39], s46 offen offset:3072 lds
    s_add_u32 s46, s46, 4096
    s_mov_b32 m0, s47
    s_add_u32 s47, s47, 4096
    buffer_load_dwordx4 v3, s[36:39], s46 offen offset:0 lds
    buffer_load_dwordx4 v3, s[36:39], s46 offen offset:1024 lds
    s_bfe_u32 s46, s3, 0x10001
    s_lshl_b32 s46, s46, 15
    s_lshr_b32 s47, s3, 2
    s_lshl_b32 s47, s47, 14
    s_add_u32 s46, s46, s47
    v_add_u32 v11, s46, v3
    s_and_b32 s46, s3, 1
    s_cmp_eq_u32 s46, 0
    s_mov_b32 s54, 0x01000c0c
    s_mov_b32 s57, 0x03020c0c
    s_cselect_b32 s57, s54, s57
    v_perm_b32 v16, v16, v16, s57
    v_perm_b32 v17, v17, v17, s57
    v_perm_b32 v18, v18, v18, s57
    v_perm_b32 v19, v19, v19, s57
    v_perm_b32 v20, v20, v20, s57
    v_perm_b32 v21, v21, v21, s57
    v_perm_b32 v22, v22, v22, s57
    v_perm_b32 v23, v23, v23, s57
    s_waitcnt vmcnt(10)
    s_barrier
    ds_read_b128 v[64:67], v11 offset:0
    ds_read_b128 v[24:27], v11 offset:1024
    ds_read_b128 v[12:15], v11 offset:2048
    ds_read_b128 v[4:7], v11 offset:3072
    s_waitcnt lgkmcnt(3)
    v_mfma_f32_32x32x16_bf16 v[84:99], v[100:103], v[64:67], 0
    ds_read_b128 v[64:67], v11 offset:4096
    s_waitcnt lgkmcnt(3)
    v_mfma_f32_32x32x16_bf16 v[84:99], v[104:107], v[24:27], v[84:99]
    ds_read_b128 v[24:27], v11 offset:5120
    s_waitcnt lgkmcnt(3)
    v_mfma_f32_32x32x16_bf16 v[84:99], v[108:111], v[12:15], v[84:99]
    ds_read_b128 v[12:15], v11 offset:6144
    s_waitcnt lgkmcnt(3)
    v_mfma_f32_32x32x16_bf16 v[84:99], v[112:115], v[4:7], v[84:99]
    ds_read_b128 v[4:7], v11 offset:7168
    s_waitcnt lgkmcnt(3)
    v_mfma_f32_32x32x16_bf16 v[84:99], v[116:119], v[64:67], v[84:99]
    ds_read_b128 v[64:67], v11 offset:8192
    s_waitcnt lgkmcnt(3)
    v_mfma_f32_32x32x16_bf16 v[84:99], v[120:123], v[24:27], v[84:99]
    ds_read_b128 v[24:27], v11 offset:9216
    s_waitcnt lgkmcnt(3)
    v_mfma_f32_32x32x16_bf16 v[84:99], v[124:127], v[12:15], v[84:99]
    ds_read_b128 v[12:15], v11 offset:10240
    s_waitcnt lgkmcnt(3)
    v_mfma_f32_32x32x16_bf16 v[84:99], v[128:131], v[4:7], v[84:99]
    ds_read_b128 v[4:7], v11 offset:11264
    s_waitcnt lgkmcnt(3)
    v_mfma_f32_32x32x16_bf16 v[84:99], v[132:135], v[64:67], v[84:99]
    ds_read_b128 v[64:67], v11 offset:12288
    s_waitcnt lgkmcnt(3)
    v_mfma_f32_32x32x16_bf16 v[84:99], v[136:139], v[24:27], v[84:99]
    ds_read_b128 v[24:27], v11 offset:13312
    s_waitcnt lgkmcnt(3)
    v_mfma_f32_32x32x16_bf16 v[84:99], v[140:143], v[12:15], v[84:99]
    ds_read_b128 v[12:15], v11 offset:14336
    s_waitcnt lgkmcnt(3)
    v_mfma_f32_32x32x16_bf16 v[84:99], v[144:147], v[4:7], v[84:99]
    ds_read_b128 v[4:7], v11 offset:15360
    s_waitcnt lgkmcnt(3)
    v_mfma_f32_32x32x16_bf16 v[84:99], v[148:151], v[64:67], v[84:99]
    s_waitcnt lgkmcnt(2)
    v_mfma_f32_32x32x16_bf16 v[84:99], v[152:155], v[24:27], v[84:99]
    s_waitcnt lgkmcnt(1)
    v_mfma_f32_32x32x16_bf16 v[84:99], v[156:159], v[12:15], v[84:99]
    s_waitcnt lgkmcnt(0)
    v_mfma_f32_32x32x16_bf16 v[84:99], v[160:163], v[4:7], v[84:99]
    s_lshl_b32 s46, s3, 11
    s_add_u32 s46, s46, 147456
    v_lshlrev_b32 v12, 5, v1
    v_add_u32 v13, s46, v12
    s_xor_b32 s46, s46, 8192
    v_add_u32 v12, s46, v12
    s_cmp_ge_u32 s3, 4
    s_cbranch_scc1 B_X1
    s_nop 3
    ds_write_b128 v13, v[92:95]
    ds_write_b128 v13, v[96:99] offset:16
    v_add_f32 v100, v84, v16
    v_add_f32 v101, v85, v17
    v_add_f32 v102, v86, v18
    v_add_f32 v103, v87, v19
    v_add_f32 v104, v88, v20
    v_add_f32 v105, v89, v21
    v_add_f32 v106, v90, v22
    v_add_f32 v107, v91, v23
    s_branch B_X2
B_X1:
    s_nop 3
    ds_write_b128 v13, v[84:87]
    ds_write_b128 v13, v[88:91] offset:16
    v_add_f32 v100, v92, v16
    v_add_f32 v101, v93, v17
    v_add_f32 v102, v94, v18
    v_add_f32 v103, v95, v19
    v_add_f32 v104, v96, v20
    v_add_f32 v105, v97, v21
    v_add_f32 v106, v98, v22
    v_add_f32 v107, v99, v23
B_X2:
    s_waitcnt lgkmcnt(0)
    s_barrier
    ds_read_b128 v[84:87], v12
    ds_read_b128 v[88:91], v12 offset:16
    s_waitcnt lgkmcnt(0)
    v_add_f32 v100, v100, v84
    v_add_f32 v101, v101, v85
    v_add_f32 v102, v102, v86
    v_add_f32 v103, v103, v87
    v_add_f32 v104, v104, v88
    v_add_f32 v105, v105, v89
    v_add_f32 v106, v106, v90
    v_add_f32 v107, v107, v91
    v_cvt_pk_bf16_f32 v12, v100, v101
    v_cvt_pk_bf16_f32 v13, v102, v103
    v_cvt_pk_bf16_f32 v14, v104, v105
    v_cvt_pk_bf16_f32 v15, v106, v107
    v_add_f32 v8, v100, v101
    v_mul_f32 v9, v100, v100
    v_fmac_f32 v9, v101, v101
    v_add_f32 v8, v8, v102
    v_fmac_f32 v9, v102, v102
    v_add_f32 v8, v8, v103
    v_fmac_f32 v9, v103, v103
    v_add_f32 v8, v8, v104
    v_fmac_f32 v9, v104, v104
    v_add_f32 v8, v8, v105
    v_fmac_f32 v9, v105, v105
    v_add_f32 v8, v8, v106
    v_fmac_f32 v9, v106, v106
    v_add_f32 v8, v8, v107
    v_fmac_f32 v9, v107, v107
    v_mov_b32 v64, v8
    v_mov_b32 v65, v9
    s_nop 0
    v_permlane32_swap_b32 v8, v64
    v_permlane32_swap_b32 v9, v65
    v_add_f32 v8, v8, v64
    v_add_f32 v9, v9, v65
    s_lshl_b32 s46, s41, 2
    s_and_b32 s47, s3, 1
    s_lshl_b32 s47, s47, 1
    s_add_u32 s46, s46, s47
    s_lshr_b32 s47, s3, 2
    s_add_u32 s46, s46, s47
    s_lshl_b32 s46, s46, 10
    s_bfe_u32 s47, s3, 0x10001
    s_lshl_b32 s47, s47, 15
    s_add_u32 s46, s46, s47
    s_add_u32 s46, s46, s52
    s_add_u32 s45, s46, 8388608
    s_lshl_b32 s46, s68, 11
    s_and_b32 s47, s3, 1
    s_lshl_b32 s47, s47, 10
    s_add_u32 s46, s46, s47
    s_lshr_b32 s47, s3, 2
    s_lshl_b32 s47, s47, 9
    s_add_u32 s46, s46, s47
    s_bfe_u32 s47, s3, 0x10001
    s_lshl_b32 s47, s47, 8
    s_add_u32 s46, s46, s47
    s_add_u32 s46, s46, 10485760
    v_lshlrev_b32 v11, 3, v1
    v_and_b32 v2, 0xff, v11
    s_cmp_eq_u32 s62, 0
    s_cbranch_scc1 HS_11
    buffer_store_dwordx4 v[12:15], v3, s[36:39], s45 offen
    buffer_store_dwordx2 v[8:9], v2, s[36:39], s46 offen
    buffer_load_dwordx4 v[84:87], v3, s[36:39], s45 offen sc1
    buffer_load_dwordx2 v[84:85], v2, s[36:39], s46 offen sc1
    s_branch HD_12
HS_11:
    buffer_store_dwordx4 v[12:15], v3, s[36:39], s45 offen sc1
    buffer_store_dwordx2 v[8:9], v2, s[36:39], s46 offen sc1
HD_12:
    s_mov_b32 s20, s64
    s_mov_b32 s21, s65
    s_mov_b32 s22, 0xe00
    s_mov_b32 s23, 0x00020000
    s_lshr_b32 s47, s53, 1
    s_lshl_b32 s47, s47, 7
    v_lshrrev_b32 v4, 5, v1
    v_lshlrev_b32 v4, 4, v4
    buffer_load_dwordx4 v[148:151], v4, s[20:23], s47 offen offset:0
    buffer_load_dwordx4 v[152:155], v4, s[20:23], s47 offen offset:32
    buffer_load_dwordx4 v[156:159], v4, s[20:23], s47 offen offset:64
    buffer_load_dwordx4 v[160:163], v4, s[20:23], s47 offen offset:96
    s_waitcnt vmcnt(4)
    s_lshl_b32 s46, s68, 7
    s_lshl_b32 s47, s3, 2
    s_add_u32 s46, s46, s47
    s_add_u32 s46, s46, 139296
    v_mov_b32 v8, 0
    v_mov_b32 v9, 1
    s_mov_b64 exec, 1
    s_cmp_eq_u32 s62, 0
    s_cbranch_scc1 FS_13
    buffer_store_dword v9, v8, s[36:39], s46 offen
    s_branch FD_14
FS_13:
    buffer_store_dword v9, v8, s[36:39], s46 offen sc1
FD_14:
    s_mov_b64 exec, -1
    s_add_u32 s49, s48, 32
    s_mov_b32 s69, 0
C_PH:
    buffer_load_dword v8, v10, s[36:39], s49 offen sc1
    s_add_u32 s69, s69, 1
    s_waitcnt vmcnt(0)
    v_cmp_eq_u32 vcc, 1, v8
    s_nop 0
    s_cmp_eq_u64 vcc, -1
    s_cbranch_scc1 C_PH_D
    s_cmp_lt_u32 s69, 40000
    s_nop 0
    s_cbranch_scc1 C_PH
C_PH_D:
    s_lshl_b32 s46, s3, 12
    s_add_u32 s47, s46, s52
    s_add_u32 s47, s47, 8388608
    s_mov_b32 m0, s46
    s_nop 0
    buffer_load_dwordx4 v3, s[36:39], s47 offen offset:0 lds
    buffer_load_dwordx4 v3, s[36:39], s47 offen offset:1024 lds
    buffer_load_dwordx4 v3, s[36:39], s47 offen offset:2048 lds
    buffer_load_dwordx4 v3, s[36:39], s47 offen offset:3072 lds
    s_add_u32 s46, s46, 32768
    s_add_u32 s47, s47, 32768
    s_mov_b32 m0, s46
    s_nop 0
    buffer_load_dwordx4 v3, s[36:39], s47 offen offset:0 lds
    buffer_load_dwordx4 v3, s[36:39], s47 offen offset:1024 lds
    buffer_load_dwordx4 v3, s[36:39], s47 offen offset:2048 lds
    buffer_load_dwordx4 v3, s[36:39], s47 offen offset:3072 lds
    s_lshl_b32 s46, s40, 3
    s_add_u32 s46, s46, s3
    s_lshl_b32 s46, s46, 11
    s_add_u32 s46, s46, 10485760
    buffer_load_dwordx2 v[84:85], v11, s[36:39], s46 offen offset:0 sc1
    buffer_load_dwordx2 v[86:87], v11, s[36:39], s46 offen offset:512 sc1
    buffer_load_dwordx2 v[88:89], v11, s[36:39], s46 offen offset:1024 sc1
    buffer_load_dwordx2 v[90:91], v11, s[36:39], s46 offen offset:1536 sc1
    s_and_b32 s47, s53, 1
    s_cmp_eq_u32 s47, 0
    s_mov_b32 s54, 0x01000c0c
    s_mov_b32 s57, 0x03020c0c
    s_cselect_b32 s57, s54, s57
    s_mov_b32 s58, 0xbfb17218
    v_mov_b32 v2, 0x3f317218
    s_mov_b32 s59, 0x3fb8aa3b
    v_perm_b32 v148, v148, v148, s57
    v_perm_b32 v149, v149, v149, s57
    v_perm_b32 v150, v150, v150, s57
    v_perm_b32 v151, v151, v151, s57
    v_perm_b32 v152, v152, v152, s57
    v_perm_b32 v153, v153, v153, s57
    v_perm_b32 v154, v154, v154, s57
    v_perm_b32 v155, v155, v155, s57
    v_perm_b32 v156, v156, v156, s57
    v_perm_b32 v157, v157, v157, s57
    v_perm_b32 v158, v158, v158, s57
    v_perm_b32 v159, v159, v159, s57
    v_perm_b32 v160, v160, v160, s57
    v_perm_b32 v161, v161, v161, s57
    v_perm_b32 v162, v162, v162, s57
    v_perm_b32 v163, v163, v163, s57
    v_mul_f32 v148, s59, v148
    v_mul_f32 v149, s59, v149
    v_mul_f32 v150, s59, v150
    v_mul_f32 v151, s59, v151
    v_mul_f32 v152, s59, v152
    v_mul_f32 v153, s59, v153
    v_mul_f32 v154, s59, v154
    v_mul_f32 v155, s59, v155
    v_mul_f32 v156, s59, v156
    v_mul_f32 v157, s59, v157
    v_mul_f32 v158, s59, v158
    v_mul_f32 v159, s59, v159
    v_mul_f32 v160, s59, v160
    v_mul_f32 v161, s59, v161
    v_mul_f32 v162, s59, v162
    v_mul_f32 v163, s59, v163
    s_lshl_b32 s50, s40, 1
    s_mul_i32 s50, s50, 112
    s_lshl_b32 s51, s53, 1
    s_add_u32 s50, s50, s51
    s_lshl_b32 s50, s50, 10
    s_add_u32 s50, s50, 12582912
    s_add_u32 s51, s50, 114688
    s_add_u32 s60, s56, 10240
    s_waitcnt vmcnt(8)
    s_waitcnt vmcnt(0)
    v_add_f32 v84, v84, v86
    v_add_f32 v85, v85, v87
    v_add_f32 v88, v88, v90
    v_add_f32 v89, v89, v91
    v_add_f32 v84, v84, v88
    v_add_f32 v85, v85, v89
    s_lshl_b32 s46, s3, 11
    s_xor_b32 s46, s46, 8192
    s_add_u32 s46, s46, 147456
    v_add_u32 v12, s46, v11
    ds_write_b64 v12, v[84:85]
    s_waitcnt lgkmcnt(0)
    s_barrier
    s_cmp_eq_u32 s3, 7
    s_cbranch_scc1 C_W7
    v_and_b32 v12, 31, v1
    v_lshlrev_b32 v12, 3, v12
    v_add_u32 v12, 147456, v12
    ds_read_b64 v[100:101], v12 offset:8192
    ds_read_b64 v[102:103], v12 offset:10240
    ds_read_b64 v[104:105], v12 offset:12288
    ds_read_b64 v[106:107], v12 offset:14336
    ds_read_b64 v[108:109], v12 offset:0
    ds_read_b64 v[110:111], v12 offset:2048
    ds_read_b64 v[112:113], v12 offset:4096
    ds_read_b64 v[114:115], v12 offset:6144
    s_waitcnt lgkmcnt(7)
    ds_read_b64 v[116:117], v12 offset:8448
    ds_read_b64 v[118:119], v12 offset:10496
    ds_read_b64 v[120:121], v12 offset:12544
    ds_read_b64 v[122:123], v12 offset:14592
    ds_read_b64 v[124:125], v12 offset:256
    ds_read_b64 v[126:127], v12 offset:2304
    ds_read_b64 v[128:129], v12 offset:4352
    ds_read_b64 v[130:131], v12 offset:6400
    s_waitcnt lgkmcnt(0)
    ds_read_b128 v[132:135], v3 offset:0
    ds_read_b128 v[136:139], v3 offset:32768
    ds_read_b128 v[140:143], v3 offset:1024
    ds_read_b128 v[144:147], v3 offset:33792
    ds_read_b128 v[84:87], v3 offset:2048
    ds_read_b128 v[88:91], v3 offset:34816
    ds_read_b128 v[92:95], v3 offset:3072
    ds_read_b128 v[96:99], v3 offset:35840
    v_add_f32 v100, v100, v108
    v_add_f32 v101, v101, v109
    v_add_f32 v102, v102, v110
    v_add_f32 v103, v103, v111
    v_add_f32 v104, v104, v112
    v_add_f32 v105, v105, v113
    v_add_f32 v106, v106, v114
    v_add_f32 v107, v107, v115
    v_add_f32 v100, v100, v104
    v_add_f32 v101, v101, v105
    v_add_f32 v102, v102, v106
    v_add_f32 v103, v103, v107
    v_add_f32 v100, v100, v102
    v_add_f32 v101, v101, v103
    v_mul_f32 v100, 0x3b000000, v100
    v_mul_f32 v101, 0x3b000000, v101
    v_fma_f32 v101, -v100, v100, v101
    v_max_f32 v101, 0, v101
    v_add_f32 v101, 0x3727c5ac, v101
    v_rsq_f32 v101, v101
    s_nop 0
    v_mul_f32 v4, s59, v101
    v_mul_f32 v5, v100, v4
    v_sub_f32 v5, 0, v5
    v_add_f32 v116, v116, v124
    v_add_f32 v117, v117, v125
    v_add_f32 v118, v118, v126
    v_add_f32 v119, v119, v127
    v_add_f32 v120, v120, v128
    v_add_f32 v121, v121, v129
    v_add_f32 v122, v122, v130
    v_add_f32 v123, v123, v131
    v_add_f32 v116, v116, v120
    v_add_f32 v117, v117, v121
    v_add_f32 v118, v118, v122
    v_add_f32 v119, v119, v123
    v_add_f32 v116, v116, v118
    v_add_f32 v117, v117, v119
    v_mul_f32 v116, 0x3b000000, v116
    v_mul_f32 v117, 0x3b000000, v117
    v_fma_f32 v117, -v116, v116, v117
    v_max_f32 v117, 0, v117
    v_add_f32 v117, 0x3727c5ac, v117
    v_rsq_f32 v117, v117
    s_nop 0
    v_mul_f32 v6, s59, v117
    v_mul_f32 v7, v116, v6
    v_sub_f32 v7, 0, v7
    s_waitcnt lgkmcnt(7)
    v_mfma_f32_32x32x16_bf16 v[100:115], v[164:167], v[132:135], 0
    ds_read_b128 v[132:135], v3 offset:4096
    s_waitcnt lgkmcnt(7)
    v_mfma_f32_32x32x16_bf16 v[116:131], v[164:167], v[136:139], 0
    ds_read_b128 v[136:139], v3 offset:36864
    buffer_load_dwordx4 v[164:167], v3, s[36:39], s60 offen offset:0
    s_waitcnt lgkmcnt(7)
    v_mfma_f32_32x32x16_bf16 v[100:115], v[168:171], v[140:143], v[100:115]
    ds_read_b128 v[140:143], v3 offset:5120
    s_waitcnt lgkmcnt(7)
    v_mfma_f32_32x32x16_bf16 v[116:131], v[168:171], v[144:147], v[116:131]
    ds_read_b128 v[144:147], v3 offset:37888
    buffer_load_dwordx4 v[168:171], v3, s[36:39], s60 offen offset:1024
    s_waitcnt lgkmcnt(7)
    v_mfma_f32_32x32x16_bf16 v[100:115], v[172:175], v[84:87], v[100:115]
    ds_read_b128 v[84:87], v3 offset:6144
    s_waitcnt lgkmcnt(7)
    v_mfma_f32_32x32x16_bf16 v[116:131], v[172:175], v[88:91], v[116:131]
    ds_read_b128 v[88:91], v3 offset:38912
    buffer_load_dwordx4 v[172:175], v3, s[36:39], s60 offen offset:2048
    s_waitcnt lgkmcnt(7)
    v_mfma_f32_32x32x16_bf16 v[100:115], v[176:179], v[92:95], v[100:115]
    ds_read_b128 v[92:95], v3 offset:7168
    s_waitcnt lgkmcnt(7)
    v_mfma_f32_32x32x16_bf16 v[116:131], v[176:179], v[96:99], v[116:131]
    ds_read_b128 v[96:99], v3 offset:39936
    buffer_load_dwordx4 v[176:179], v3, s[36:39], s60 offen offset:3072
    s_add_u32 s60, s60, 4096
    s_waitcnt lgkmcnt(7)
    v_mfma_f32_32x32x16_bf16 v[100:115], v[180:183], v[132:135], v[100:115]
    ds_read_b128 v[132:135], v3 offset:8192
    s_waitcnt lgkmcnt(7)
    v_mfma_f32_32x32x16_bf16 v[116:131], v[180:183], v[136:139], v[116:131]
    ds_read_b128 v[136:139], v3 offset:40960
    buffer_load_dwordx4 v[180:183], v3, s[36:39], s60 offen offset:0
    s_waitcnt lgkmcnt(7)
    v_mfma_f32_32x32x16_bf16 v[100:115], v[184:187], v[140:143], v[100:115]
    ds_read_b128 v[140:143], v3 offset:9216
    s_waitcnt lgkmcnt(7)
    v_mfma_f32_32x32x16_bf16 v[116:131], v[184:187], v[144:147], v[116:131]
    ds_read_b128 v[144:147], v3 offset:41984
    buffer_load_dwordx4 v[184:187], v3, s[36:39], s60 offen offset:1024
    s_waitcnt lgkmcnt(7)
    v_mfma_f32_32x32x16_bf16 v[100:115], v[188:191], v[84:87], v[100:115]
    ds_read_b128 v[84:87], v3 offset:10240
    s_waitcnt lgkmcnt(7)
    v_mfma_f32_32x32x16_bf16 v[116:131], v[188:191], v[88:91], v[116:131]
    ds_read_b128 v[88:91], v3 offset:43008
    buffer_load_dwordx4 v[188:191], v3, s[36:39], s60 offen offset:2048
    s_waitcnt lgkmcnt(7)
    v_mfma_f32_32x32x16_bf16 v[100:115], v[192:195], v[92:95], v[100:115]
    ds_read_b128 v[92:95], v3 offset:11264
    s_waitcnt lgkmcnt(7)
    v_mfma_f32_32x32x16_bf16 v[116:131], v[192:195], v[96:99], v[116:131]
    ds_read_b128 v[96:99], v3 offset:44032
    buffer_load_dwordx4 v[192:195], v3, s[36:39], s60 offen offset:3072
    s_add_u32 s60, s60, 4096
    s_waitcnt lgkmcnt(7)
    v_mfma_f32_32x32x16_bf16 v[100:115], v[196:199], v[132:135], v[100:115]
    ds_read_b128 v[132:135], v3 offset:12288
    s_waitcnt lgkmcnt(7)
    v_mfma_f32_32x32x16_bf16 v[116:131], v[196:199], v[136:139], v[116:131]
    ds_read_b128 v[136:139], v3 offset:45056
    buffer_load_dwordx4 v[196:199], v3, s[36:39], s60 offen offset:0
    s_waitcnt lgkmcnt(7)
    v_mfma_f32_32x32x16_bf16 v[100:115], v[200:203], v[140:143], v[100:115]
    ds_read_b128 v[140:143], v3 offset:13312
    s_waitcnt lgkmcnt(7)
    v_mfma_f32_32x32x16_bf16 v[116:131], v[200:203], v[144:147], v[116:131]
    ds_read_b128 v[144:147], v3 offset:46080
    buffer_load_dwordx4 v[200:203], v3, s[36:39], s60 offen offset:1024
    s_waitcnt lgkmcnt(7)
    v_mfma_f32_32x32x16_bf16 v[100:115], v[204:207], v[84:87], v[100:115]
    ds_read_b128 v[84:87], v3 offset:14336
    s_waitcnt lgkmcnt(7)
    v_mfma_f32_32x32x16_bf16 v[116:131], v[204:207], v[88:91], v[116:131]
    ds_read_b128 v[88:91], v3 offset:47104
    buffer_load_dwordx4 v[204:207], v3, s[36:39], s60 offen offset:2048
    s_waitcnt lgkmcnt(7)
    v_mfma_f32_32x32x16_bf16 v[100:115], v[208:211], v[92:95], v[100:115]
    ds_read_b128 v[92:95], v3 offset:15360
    s_waitcnt lgkmcnt(7)
    v_mfma_f32_32x32x16_bf16 v[116:131], v[208:211], v[96:99], v[116:131]
    ds_read_b128 v[96:99], v3 offset:48128
    buffer_load_dwordx4 v[208:211], v3, s[36:39], s60 offen offset:3072
    s_add_u32 s60, s60, 4096
    s_waitcnt lgkmcnt(7)
    v_mfma_f32_32x32x16_bf16 v[100:115], v[212:215], v[132:135], v[100:115]
    ds_read_b128 v[132:135], v3 offset:16384
    s_waitcnt lgkmcnt(7)
    v_mfma_f32_32x32x16_bf16 v[116:131], v[212:215], v[136:139], v[116:131]
    ds_read_b128 v[136:139], v3 offset:49152
    buffer_load_dwordx4 v[212:215], v3, s[36:39], s60 offen offset:0
    s_waitcnt lgkmcnt(7)
    v_mfma_f32_32x32x16_bf16 v[100:115], v[216:219], v[140:143], v[100:115]
    ds_read_b128 v[140:143], v3 offset:17408
    s_waitcnt lgkmcnt(7)
    v_mfma_f32_32x32x16_bf16 v[116:131], v[216:219], v[144:147], v[116:131]
    ds_read_b128 v[144:147], v3 offset:50176
    buffer_load_dwordx4 v[216:219], v3, s[36:39], s60 offen offset:1024
    s_waitcnt lgkmcnt(7)
    v_mfma_f32_32x32x16_bf16 v[100:115], v[220:223], v[84:87], v[100:115]
    ds_read_b128 v[84:87], v3 offset:18432
    s_waitcnt lgkmcnt(7)
    v_mfma_f32_32x32x16_bf16 v[116:131], v[220:223], v[88:91], v[116:131]
    ds_read_b128 v[88:91], v3 offset:51200
    buffer_load_dwordx4 v[220:223], v3, s[36:39], s60 offen offset:2048
    s_waitcnt lgkmcnt(7)
    v_mfma_f32_32x32x16_bf16 v[100:115], v[224:227], v[92:95], v[100:115]
    ds_read_b128 v[92:95], v3 offset:19456
    s_waitcnt lgkmcnt(7)
    v_mfma_f32_32x32x16_bf16 v[116:131], v[224:227], v[96:99], v[116:131]
    ds_read_b128 v[96:99], v3 offset:52224
    buffer_load_dwordx4 v[224:227], v3, s[36:39], s60 offen offset:3072
    s_add_u32 s60, s60, 4096
    s_waitcnt lgkmcnt(7)
    v_mfma_f32_32x32x16_bf16 v[100:115], v[228:231], v[132:135], v[100:115]
    ds_read_b128 v[132:135], v3 offset:20480
    s_waitcnt lgkmcnt(7)
    v_mfma_f32_32x32x16_bf16 v[116:131], v[228:231], v[136:139], v[116:131]
    ds_read_b128 v[136:139], v3 offset:53248
    buffer_load_dwordx4 v[228:231], v3, s[36:39], s60 offen offset:0
    s_waitcnt lgkmcnt(7)
    v_mfma_f32_32x32x16_bf16 v[100:115], v[232:235], v[140:143], v[100:115]
    ds_read_b128 v[140:143], v3 offset:21504
    s_waitcnt lgkmcnt(7)
    v_mfma_f32_32x32x16_bf16 v[116:131], v[232:235], v[144:147], v[116:131]
    ds_read_b128 v[144:147], v3 offset:54272
    buffer_load_dwordx4 v[232:235], v3, s[36:39], s60 offen offset:1024
    s_waitcnt lgkmcnt(7)
    v_mfma_f32_32x32x16_bf16 v[100:115], v[236:239], v[84:87], v[100:115]
    ds_read_b128 v[84:87], v3 offset:22528
    s_waitcnt lgkmcnt(7)
    v_mfma_f32_32x32x16_bf16 v[116:131], v[236:239], v[88:91], v[116:131]
    ds_read_b128 v[88:91], v3 offset:55296
    s_waitcnt lgkmcnt(7)
    v_mfma_f32_32x32x16_bf16 v[100:115], v[240:243], v[92:95], v[100:115]
    ds_read_b128 v[92:95], v3 offset:23552
    s_waitcnt lgkmcnt(7)
    v_mfma_f32_32x32x16_bf16 v[116:131], v[240:243], v[96:99], v[116:131]
    ds_read_b128 v[96:99], v3 offset:56320
    s_waitcnt lgkmcnt(7)
    v_mfma_f32_32x32x16_bf16 v[100:115], v[244:247], v[132:135], v[100:115]
    ds_read_b128 v[132:135], v3 offset:24576
    s_waitcnt lgkmcnt(7)
    v_mfma_f32_32x32x16_bf16 v[116:131], v[244:247], v[136:139], v[116:131]
    ds_read_b128 v[136:139], v3 offset:57344
    s_waitcnt lgkmcnt(7)
    v_mfma_f32_32x32x16_bf16 v[100:115], v[248:251], v[140:143], v[100:115]
    ds_read_b128 v[140:143], v3 offset:25600
    s_waitcnt lgkmcnt(7)
    v_mfma_f32_32x32x16_bf16 v[116:131], v[248:251], v[144:147], v[116:131]
    ds_read_b128 v[144:147], v3 offset:58368
    s_waitcnt lgkmcnt(7)
    v_mfma_f32_32x32x16_bf16 v[100:115], v[252:255], v[84:87], v[100:115]
    ds_read_b128 v[84:87], v3 offset:26624
    s_waitcnt lgkmcnt(7)
    v_mfma_f32_32x32x16_bf16 v[116:131], v[252:255], v[88:91], v[116:131]
    ds_read_b128 v[88:91], v3 offset:59392
    s_waitcnt lgkmcnt(7)
    v_mfma_f32_32x32x16_bf16 v[100:115], v[28:31], v[92:95], v[100:115]
    ds_read_b128 v[92:95], v3 offset:27648
    s_waitcnt lgkmcnt(7)
    v_mfma_f32_32x32x16_bf16 v[116:131], v[28:31], v[96:99], v[116:131]
    ds_read_b128 v[96:99], v3 offset:60416
    s_waitcnt lgkmcnt(7)
    v_mfma_f32_32x32x16_bf16 v[100:115], v[32:35], v[132:135], v[100:115]
    ds_read_b128 v[132:135], v3 offset:28672
    s_waitcnt lgkmcnt(7)
    v_mfma_f32_32x32x16_bf16 v[116:131], v[32:35], v[136:139], v[116:131]
    ds_read_b128 v[136:139], v3 offset:61440
    s_waitcnt lgkmcnt(7)
    v_mfma_f32_32x32x16_bf16 v[100:115], v[36:39], v[140:143], v[100:115]
    ds_read_b128 v[140:143], v3 offset:29696
    s_waitcnt lgkmcnt(7)
    v_mfma_f32_32x32x16_bf16 v[116:131], v[36:39], v[144:147], v[116:131]
    ds_read_b128 v[144:147], v3 offset:62464
    s_waitcnt lgkmcnt(7)
    v_mfma_f32_32x32x16_bf16 v[100:115], v[40:43], v[84:87], v[100:115]
    ds_read_b128 v[84:87], v3 offset:30720
    s_waitcnt lgkmcnt(7)
    v_mfma_f32_32x32x16_bf16 v[116:131], v[40:43], v[88:91], v[116:131]
    ds_read_b128 v[88:91], v3 offset:63488
    s_waitcnt lgkmcnt(7)
    v_mfma_f32_32x32x16_bf16 v[100:115], v[44:47], v[92:95], v[100:115]
    ds_read_b128 v[92:95], v3 offset:31744
    s_waitcnt lgkmcnt(7)
    v_mfma_f32_32x32x16_bf16 v[116:131], v[44:47], v[96:99], v[116:131]
    ds_read_b128 v[96:99], v3 offset:64512
    s_waitcnt lgkmcnt(7)
    v_mfma_f32_32x32x16_bf16 v[100:115], v[48:51], v[132:135], v[100:115]
    s_waitcnt lgkmcnt(6)
    v_mfma_f32_32x32x16_bf16 v[116:131], v[48:51], v[136:139], v[116:131]
    s_waitcnt lgkmcnt(5)
    v_mfma_f32_32x32x16_bf16 v[100:115], v[52:55], v[140:143], v[100:115]
    s_waitcnt lgkmcnt(4)
    v_mfma_f32_32x32x16_bf16 v[116:131], v[52:55], v[144:147], v[116:131]
    s_waitcnt lgkmcnt(3)
    v_mfma_f32_32x32x16_bf16 v[100:115], v[56:59], v[84:87], v[100:115]
    s_waitcnt lgkmcnt(2)
    v_mfma_f32_32x32x16_bf16 v[116:131], v[56:59], v[88:91], v[116:131]
    s_waitcnt lgkmcnt(1)
    v_mfma_f32_32x32x16_bf16 v[100:115], v[60:63], v[92:95], v[100:115]
    s_waitcnt lgkmcnt(0)
    v_mfma_f32_32x32x16_bf16 v[116:131], v[60:63], v[96:99], v[116:131]
    v_fma_f32 v8, v5, v68, v148
    v_fma_f32 v10, v5, v69, v149
    v_fma_f32 v12, v5, v70, v150
    v_fma_f32 v14, v5, v71, v151
    s_nop 5
    v_fma_f32 v100, v4, v100, v8
    v_fma_f32 v101, v4, v101, v10
    v_fma_f32 v102, v4, v102, v12
    v_fma_f32 v103, v4, v103, v14
    v_exp_f32 v8, v100
    v_exp_f32 v10, v101
    v_exp_f32 v12, v102
    v_exp_f32 v14, v103
    v_add_f32 v9, 2.0, v8
    v_add_f32 v11, 2.0, v10
    v_add_f32 v13, 2.0, v12
    v_add_f32 v15, 2.0, v14
    v_fma_f32 v8, v8, v9, 2.0
    v_fma_f32 v10, v10, v11, 2.0
    v_fma_f32 v12, v12, v13, 2.0
    v_fma_f32 v14, v14, v15, 2.0
    v_rcp_f32 v8, v8
    v_rcp_f32 v10, v10
    v_rcp_f32 v12, v12
    v_rcp_f32 v14, v14
    v_fma_f32 v8, v8, s58, v2
    v_fma_f32 v10, v10, s58, v2
    v_fma_f32 v12, v12, s58, v2
    v_fma_f32 v14, v14, s58, v2
    v_mul_f32 v100, v100, v8
    v_mul_f32 v101, v101, v10
    v_mul_f32 v102, v102, v12
    v_mul_f32 v103, v103, v14
    v_cvt_pk_bf16_f32 v84, v100, v101
    v_cvt_pk_bf16_f32 v85, v102, v103
    v_fma_f32 v8, v5, v72, v152
    v_fma_f32 v10, v5, v73, v153
    v_fma_f32 v12, v5, v74, v154
    v_fma_f32 v14, v5, v75, v155
    v_fma_f32 v104, v4, v104, v8
    v_fma_f32 v105, v4, v105, v10
    v_fma_f32 v106, v4, v106, v12
    v_fma_f32 v107, v4, v107, v14
    v_exp_f32 v8, v104
    v_exp_f32 v10, v105
    v_exp_f32 v12, v106
    v_exp_f32 v14, v107
    v_add_f32 v9, 2.0, v8
    v_add_f32 v11, 2.0, v10
    v_add_f32 v13, 2.0, v12
    v_add_f32 v15, 2.0, v14
    v_fma_f32 v8, v8, v9, 2.0
    v_fma_f32 v10, v10, v11, 2.0
    v_fma_f32 v12, v12, v13, 2.0
    v_fma_f32 v14, v14, v15, 2.0
    v_rcp_f32 v8, v8
    v_rcp_f32 v10, v10
    v_rcp_f32 v12, v12
    v_rcp_f32 v14, v14
    v_fma_f32 v8, v8, s58, v2
    v_fma_f32 v10, v10, s58, v2
    v_fma_f32 v12, v12, s58, v2
    v_fma_f32 v14, v14, s58, v2
    v_mul_f32 v104, v104, v8
    v_mul_f32 v105, v105, v10
    v_mul_f32 v106, v106, v12
    v_mul_f32 v107, v107, v14
    v_cvt_pk_bf16_f32 v86, v104, v105
    v_cvt_pk_bf16_f32 v87, v106, v107
    v_fma_f32 v8, v5, v76, v156
    v_fma_f32 v10, v5, v77, v157
    v_fma_f32 v12, v5, v78, v158
    v_fma_f32 v14, v5, v79, v159
    v_fma_f32 v108, v4, v108, v8
    v_fma_f32 v109, v4, v109, v10
    v_fma_f32 v110, v4, v110, v12
    v_fma_f32 v111, v4, v111, v14
    v_exp_f32 v8, v108
    v_exp_f32 v10, v109
    v_exp_f32 v12, v110
    v_exp_f32 v14, v111
    v_add_f32 v9, 2.0, v8
    v_add_f32 v11, 2.0, v10
    v_add_f32 v13, 2.0, v12
    v_add_f32 v15, 2.0, v14
    v_fma_f32 v8, v8, v9, 2.0
    v_fma_f32 v10, v10, v11, 2.0
    v_fma_f32 v12, v12, v13, 2.0
    v_fma_f32 v14, v14, v15, 2.0
    v_rcp_f32 v8, v8
    v_rcp_f32 v10, v10
    v_rcp_f32 v12, v12
    v_rcp_f32 v14, v14
    v_fma_f32 v8, v8, s58, v2
    v_fma_f32 v10, v10, s58, v2
    v_fma_f32 v12, v12, s58, v2
    v_fma_f32 v14, v14, s58, v2
    v_mul_f32 v108, v108, v8
    v_mul_f32 v109, v109, v10
    v_mul_f32 v110, v110, v12
    v_mul_f32 v111, v111, v14
    v_cvt_pk_bf16_f32 v88, v108, v109
    v_cvt_pk_bf16_f32 v89, v110, v111
    v_fma_f32 v8, v5, v80, v160
    v_fma_f32 v10, v5, v81, v161
    v_fma_f32 v12, v5, v82, v162
    v_fma_f32 v14, v5, v83, v163
    v_fma_f32 v112, v4, v112, v8
    v_fma_f32 v113, v4, v113, v10
    v_fma_f32 v114, v4, v114, v12
    v_fma_f32 v115, v4, v115, v14
    v_exp_f32 v8, v112
    v_exp_f32 v10, v113
    v_exp_f32 v12, v114
    v_exp_f32 v14, v115
    v_add_f32 v9, 2.0, v8
    v_add_f32 v11, 2.0, v10
    v_add_f32 v13, 2.0, v12
    v_add_f32 v15, 2.0, v14
    v_fma_f32 v8, v8, v9, 2.0
    v_fma_f32 v10, v10, v11, 2.0
    v_fma_f32 v12, v12, v13, 2.0
    v_fma_f32 v14, v14, v15, 2.0
    v_rcp_f32 v8, v8
    v_rcp_f32 v10, v10
    v_rcp_f32 v12, v12
    v_rcp_f32 v14, v14
    v_fma_f32 v8, v8, s58, v2
    v_fma_f32 v10, v10, s58, v2
    v_fma_f32 v12, v12, s58, v2
    v_fma_f32 v14, v14, s58, v2
    v_mul_f32 v112, v112, v8
    v_mul_f32 v113, v113, v10
    v_mul_f32 v114, v114, v12
    v_mul_f32 v115, v115, v14
    v_cvt_pk_bf16_f32 v90, v112, v113
    v_cvt_pk_bf16_f32 v91, v114, v115
    v_fma_f32 v8, v7, v68, v148
    v_fma_f32 v10, v7, v69, v149
    v_fma_f32 v12, v7, v70, v150
    v_fma_f32 v14, v7, v71, v151
    v_fma_f32 v116, v6, v116, v8
    v_fma_f32 v117, v6, v117, v10
    v_fma_f32 v118, v6, v118, v12
    v_fma_f32 v119, v6, v119, v14
    v_exp_f32 v8, v116
    v_exp_f32 v10, v117
    v_exp_f32 v12, v118
    v_exp_f32 v14, v119
    v_add_f32 v9, 2.0, v8
    v_add_f32 v11, 2.0, v10
    v_add_f32 v13, 2.0, v12
    v_add_f32 v15, 2.0, v14
    v_fma_f32 v8, v8, v9, 2.0
    v_fma_f32 v10, v10, v11, 2.0
    v_fma_f32 v12, v12, v13, 2.0
    v_fma_f32 v14, v14, v15, 2.0
    v_rcp_f32 v8, v8
    v_rcp_f32 v10, v10
    v_rcp_f32 v12, v12
    v_rcp_f32 v14, v14
    v_fma_f32 v8, v8, s58, v2
    v_fma_f32 v10, v10, s58, v2
    v_fma_f32 v12, v12, s58, v2
    v_fma_f32 v14, v14, s58, v2
    v_mul_f32 v116, v116, v8
    v_mul_f32 v117, v117, v10
    v_mul_f32 v118, v118, v12
    v_mul_f32 v119, v119, v14
    v_cvt_pk_bf16_f32 v92, v116, v117
    v_cvt_pk_bf16_f32 v93, v118, v119
    v_fma_f32 v8, v7, v72, v152
    v_fma_f32 v10, v7, v73, v153
    v_fma_f32 v12, v7, v74, v154
    v_fma_f32 v14, v7, v75, v155
    v_fma_f32 v120, v6, v120, v8
    v_fma_f32 v121, v6, v121, v10
    v_fma_f32 v122, v6, v122, v12
    v_fma_f32 v123, v6, v123, v14
    v_exp_f32 v8, v120
    v_exp_f32 v10, v121
    v_exp_f32 v12, v122
    v_exp_f32 v14, v123
    v_add_f32 v9, 2.0, v8
    v_add_f32 v11, 2.0, v10
    v_add_f32 v13, 2.0, v12
    v_add_f32 v15, 2.0, v14
    v_fma_f32 v8, v8, v9, 2.0
    v_fma_f32 v10, v10, v11, 2.0
    v_fma_f32 v12, v12, v13, 2.0
    v_fma_f32 v14, v14, v15, 2.0
    v_rcp_f32 v8, v8
    v_rcp_f32 v10, v10
    v_rcp_f32 v12, v12
    v_rcp_f32 v14, v14
    v_fma_f32 v8, v8, s58, v2
    v_fma_f32 v10, v10, s58, v2
    v_fma_f32 v12, v12, s58, v2
    v_fma_f32 v14, v14, s58, v2
    v_mul_f32 v120, v120, v8
    v_mul_f32 v121, v121, v10
    v_mul_f32 v122, v122, v12
    v_mul_f32 v123, v123, v14
    v_cvt_pk_bf16_f32 v94, v120, v121
    v_cvt_pk_bf16_f32 v95, v122, v123
    v_fma_f32 v8, v7, v76, v156
    v_fma_f32 v10, v7, v77, v157
    v_fma_f32 v12, v7, v78, v158
    v_fma_f32 v14, v7, v79, v159
    v_fma_f32 v124, v6, v124, v8
    v_fma_f32 v125, v6, v125, v10
    v_fma_f32 v126, v6, v126, v12
    v_fma_f32 v127, v6, v127, v14
    v_exp_f32 v8, v124
    v_exp_f32 v10, v125
    v_exp_f32 v12, v126
    v_exp_f32 v14, v127
    v_add_f32 v9, 2.0, v8
    v_add_f32 v11, 2.0, v10
    v_add_f32 v13, 2.0, v12
    v_add_f32 v15, 2.0, v14
    v_fma_f32 v8, v8, v9, 2.0
    v_fma_f32 v10, v10, v11, 2.0
    v_fma_f32 v12, v12, v13, 2.0
    v_fma_f32 v14, v14, v15, 2.0
    v_rcp_f32 v8, v8
    v_rcp_f32 v10, v10
    v_rcp_f32 v12, v12
    v_rcp_f32 v14, v14
    v_fma_f32 v8, v8, s58, v2
    v_fma_f32 v10, v10, s58, v2
    v_fma_f32 v12, v12, s58, v2
    v_fma_f32 v14, v14, s58, v2
    v_mul_f32 v124, v124, v8
    v_mul_f32 v125, v125, v10
    v_mul_f32 v126, v126, v12
    v_mul_f32 v127, v127, v14
    v_cvt_pk_bf16_f32 v96, v124, v125
    v_cvt_pk_bf16_f32 v97, v126, v127
    v_fma_f32 v8, v7, v80, v160
    v_fma_f32 v10, v7, v81, v161
    v_fma_f32 v12, v7, v82, v162
    v_fma_f32 v14, v7, v83, v163
    v_fma_f32 v128, v6, v128, v8
    v_fma_f32 v129, v6, v129, v10
    v_fma_f32 v130, v6, v130, v12
    v_fma_f32 v131, v6, v131, v14
    v_exp_f32 v8, v128
    v_exp_f32 v10, v129
    v_exp_f32 v12, v130
    v_exp_f32 v14, v131
    v_add_f32 v9, 2.0, v8
    v_add_f32 v11, 2.0, v10
    v_add_f32 v13, 2.0, v12
    v_add_f32 v15, 2.0, v14
    v_fma_f32 v8, v8, v9, 2.0
    v_fma_f32 v10, v10, v11, 2.0
    v_fma_f32 v12, v12, v13, 2.0
    v_fma_f32 v14, v14, v15, 2.0
    v_rcp_f32 v8, v8
    v_rcp_f32 v10, v10
    v_rcp_f32 v12, v12
    v_rcp_f32 v14, v14
    v_fma_f32 v8, v8, s58, v2
    v_fma_f32 v10, v10, s58, v2
    v_fma_f32 v12, v12, s58, v2
    v_fma_f32 v14, v14, s58, v2
    v_mul_f32 v128, v128, v8
    v_mul_f32 v129, v129, v10
    v_mul_f32 v130, v130, v12
    v_mul_f32 v131, v131, v14
    v_cvt_pk_bf16_f32 v98, v128, v129
    v_cvt_pk_bf16_f32 v99, v130, v131
    s_cmp_eq_u32 s62, 0
    s_cbranch_scc1 HS_15
    buffer_store_dwordx4 v[84:87], v3, s[36:39], s50 offen
    buffer_store_dwordx4 v[88:91], v3, s[36:39], s50 offen offset:1024
    buffer_store_dwordx4 v[92:95], v3, s[36:39], s51 offen
    buffer_store_dwordx4 v[96:99], v3, s[36:39], s51 offen offset:1024
    buffer_load_dwordx4 v[132:135], v3, s[36:39], s50 offen sc1
    buffer_load_dwordx4 v[132:135], v3, s[36:39], s50 offen offset:1024 sc1
    buffer_load_dwordx4 v[132:135], v3, s[36:39], s51 offen sc1
    buffer_load_dwordx4 v[132:135], v3, s[36:39], s51 offen offset:1024 sc1
    s_branch HD_16
HS_15:
    buffer_store_dwordx4 v[84:87], v3, s[36:39], s50 offen sc1
    buffer_store_dwordx4 v[88:91], v3, s[36:39], s50 offen offset:1024 sc1
    buffer_store_dwordx4 v[92:95], v3, s[36:39], s51 offen sc1
    buffer_store_dwordx4 v[96:99], v3, s[36:39], s51 offen offset:1024 sc1
HD_16:
    s_branch C_END
C_W7:
    buffer_load_dwordx4 v[164:167], v3, s[36:39], s60 offen offset:0
    buffer_load_dwordx4 v[168:171], v3, s[36:39], s60 offen offset:1024
    buffer_load_dwordx4 v[172:175], v3, s[36:39], s60 offen offset:2048
    buffer_load_dwordx4 v[176:179], v3, s[36:39], s60 offen offset:3072
    s_add_u32 s60, s60, 4096
    buffer_load_dwordx4 v[180:183], v3, s[36:39], s60 offen offset:0
    buffer_load_dwordx4 v[184:187], v3, s[36:39], s60 offen offset:1024
    buffer_load_dwordx4 v[188:191], v3, s[36:39], s60 offen offset:2048
    buffer_load_dwordx4 v[192:195], v3, s[36:39], s60 offen offset:3072
    s_add_u32 s60, s60, 4096
    buffer_load_dwordx4 v[196:199], v3, s[36:39], s60 offen offset:0
    buffer_load_dwordx4 v[200:203], v3, s[36:39], s60 offen offset:1024
    buffer_load_dwordx4 v[204:207], v3, s[36:39], s60 offen offset:2048
    buffer_load_dwordx4 v[208:211], v3, s[36:39], s60 offen offset:3072
    s_add_u32 s60, s60, 4096
    buffer_load_dwordx4 v[212:215], v3, s[36:39], s60 offen offset:0
    buffer_load_dwordx4 v[216:219], v3, s[36:39], s60 offen offset:1024
    buffer_load_dwordx4 v[220:223], v3, s[36:39], s60 offen offset:2048
    buffer_load_dwordx4 v[224:227], v3, s[36:39], s60 offen offset:3072
    s_add_u32 s60, s60, 4096
    buffer_load_dwordx4 v[228:231], v3, s[36:39], s60 offen offset:0
    buffer_load_dwordx4 v[232:235], v3, s[36:39], s60 offen offset:1024
C_END:
    s_waitcnt vmcnt(0)
    s_lshl_b32 s46, s68, 7
    s_lshl_b32 s47, s3, 2
    s_add_u32 s46, s46, s47
    s_add_u32 s46, s46, 139328
    v_mov_b32 v8, 0
    v_mov_b32 v9, 1
    s_mov_b64 exec, 1
    s_cmp_eq_u32 s62, 0
    s_cbranch_scc1 FS_17
    buffer_store_dword v9, v8, s[36:39], s46 offen
    s_branch FD_18
FS_17:
    buffer_store_dword v9, v8, s[36:39], s46 offen sc1
FD_18:
    s_mov_b64 exec, -1
    v_lshrrev_b32 v60, 3, v0
    v_and_b32 v61, 7, v0
    v_lshrrev_b32 v62, 5, v60
    v_lshlrev_b32 v62, 15, v62
    v_and_b32 v63, 31, v60
    v_lshl_add_u32 v62, v63, 4, v62
    v_and_b32 v63, 1, v61
    v_lshl_add_u32 v62, v63, 9, v62
    v_bfe_u32 v63, v61, 1, 1
    v_lshl_add_u32 v62, v63, 3, v62
    v_lshrrev_b32 v63, 2, v61
    v_lshl_add_u32 v62, v63, 10, v62
    s_lshl_b32 s46, s41, 12
    v_add_u32 v62, s46, v62
    ds_read_b64 v[64:65], v62
    ds_read_b64 v[66:67], v62 offset:2048
    v_lshlrev_b32 v62, 10, v60
    v_lshl_add_u32 v62, v61, 4, v62
    s_lshl_b32 s53, s41, 7
    s_add_u32 s53, s53, s52
    s_mov_b32 s20, s16
    s_mov_b32 s21, s17
    s_mov_b32 s22, 0x200000
    s_mov_b32 s23, 0x00020000
    s_lshl_b32 s50, s40, 1
    s_mul_i32 s50, s50, 112
    s_mul_i32 s51, s3, 14
    s_add_u32 s50, s50, s51
    s_lshl_b32 s50, s50, 10
    s_add_u32 s50, s50, 12582912
    s_add_u32 s51, s50, 114688
    s_add_u32 s47, s3, 5
    s_and_b32 s47, s47, 7
    s_mul_i32 s47, s47, 10240
    s_add_u32 s47, s47, 65536
    v_add_u32 v63, s47, v3
    s_waitcnt lgkmcnt(0)
    s_barrier
    v_and_b32 v2, 7, v1
    v_lshlrev_b32 v2, 2, v2
    s_add_u32 s46, s48, 64
    s_mov_b32 s69, 0
D_PA:
    buffer_load_dword v59, v2, s[36:39], s46 offen sc1
    s_add_u32 s69, s69, 1
    s_waitcnt vmcnt(0)
    v_cmp_eq_u32 vcc, 1, v59
    s_nop 0
    s_cmp_eq_u64 vcc, -1
    s_cbranch_scc1 D_PA_D
    s_cmp_lt_u32 s69, 40000
    s_nop 0
    s_cbranch_scc1 D_PA
D_PA_D:
    buffer_load_dwordx4 v[4:7], v3, s[36:39], s50 offen offset:0
    buffer_load_dwordx4 v[8:11], v3, s[36:39], s51 offen offset:0
    buffer_load_dwordx4 v[12:15], v3, s[36:39], s50 offen offset:1024
    buffer_load_dwordx4 v[16:19], v3, s[36:39], s51 offen offset:1024
    buffer_load_dwordx4 v[20:23], v3, s[36:39], s50 offen offset:2048
    buffer_load_dwordx4 v[24:27], v3, s[36:39], s51 offen offset:2048
    buffer_load_dwordx4 v[28:31], v3, s[36:39], s50 offen offset:3072
    s_add_u32 s50, s50, 4096
    buffer_load_dwordx4 v[32:35], v3, s[36:39], s51 offen offset:3072
    s_add_u32 s51, s51, 4096
    buffer_load_dwordx4 v[36:39], v3, s[36:39], s50 offen offset:0
    buffer_load_dwordx4 v[40:43], v3, s[36:39], s51 offen offset:0
    buffer_load_dwordx4 v[44:47], v3, s[36:39], s50 offen offset:1024
    buffer_load_dwordx4 v[48:51], v3, s[36:39], s51 offen offset:1024
    buffer_load_dwordx4 v[52:55], v3, s[36:39], s50 offen offset:2048
    buffer_load_dwordx4 v[56:59], v3, s[36:39], s50 offen offset:3072
    s_add_u32 s50, s50, 4096
    ds_read_b128 v[236:239], v63 offset:0
    ds_read_b128 v[240:243], v63 offset:1024
    ds_read_b128 v[244:247], v63 offset:2048
    ds_read_b128 v[248:251], v63 offset:3072
    s_waitcnt vmcnt(13) lgkmcnt(2)
    v_mfma_f32_32x32x16_bf16 v[100:115], v[236:239], v[4:7], 0
    v_mfma_f32_32x32x16_bf16 v[116:131], v[240:243], v[4:7], 0
    buffer_load_dwordx4 v[4:7], v3, s[36:39], s50 offen offset:0
    s_waitcnt vmcnt(13)
    v_mfma_f32_32x32x16_bf16 v[132:147], v[236:239], v[8:11], 0
    v_mfma_f32_32x32x16_bf16 v[148:163], v[240:243], v[8:11], 0
    buffer_load_dwordx4 v[8:11], v3, s[36:39], s50 offen offset:1024
    ds_read_b128 v[236:239], v63 offset:4096
    ds_read_b128 v[240:243], v63 offset:5120
    s_waitcnt vmcnt(13) lgkmcnt(2)
    v_mfma_f32_32x32x16_bf16 v[100:115], v[244:247], v[12:15], v[100:115]
    v_mfma_f32_32x32x16_bf16 v[116:131], v[248:251], v[12:15], v[116:131]
    buffer_load_dwordx4 v[12:15], v3, s[36:39], s50 offen offset:2048
    s_waitcnt vmcnt(13)
    v_mfma_f32_32x32x16_bf16 v[132:147], v[244:247], v[16:19], v[132:147]
    v_mfma_f32_32x32x16_bf16 v[148:163], v[248:251], v[16:19], v[148:163]
    buffer_load_dwordx4 v[16:19], v3, s[36:39], s50 offen offset:3072
    s_add_u32 s50, s50, 4096
    ds_read_b128 v[244:247], v63 offset:6144
    ds_read_b128 v[248:251], v63 offset:7168
    s_waitcnt vmcnt(13) lgkmcnt(2)
    v_mfma_f32_32x32x16_bf16 v[100:115], v[236:239], v[20:23], v[100:115]
    v_mfma_f32_32x32x16_bf16 v[116:131], v[240:243], v[20:23], v[116:131]
    buffer_load_dwordx4 v[20:23], v3, s[36:39], s50 offen offset:0
    s_waitcnt vmcnt(13)
    v_mfma_f32_32x32x16_bf16 v[132:147], v[236:239], v[24:27], v[132:147]
    v_mfma_f32_32x32x16_bf16 v[148:163], v[240:243], v[24:27], v[148:163]
    buffer_load_dwordx4 v[24:27], v3, s[36:39], s50 offen offset:1024
    ds_read_b128 v[236:239], v63 offset:8192
    ds_read_b128 v[240:243], v63 offset:9216
    s_waitcnt vmcnt(13) lgkmcnt(2)
    v_mfma_f32_32x32x16_bf16 v[100:115], v[244:247], v[28:31], v[100:115]
    v_mfma_f32_32x32x16_bf16 v[116:131], v[248:251], v[28:31], v[116:131]
    buffer_load_dwordx4 v[28:31], v3, s[36:39], s51 offen offset:2048
    s_waitcnt vmcnt(13)
    v_mfma_f32_32x32x16_bf16 v[132:147], v[244:247], v[32:35], v[132:147]
    v_mfma_f32_32x32x16_bf16 v[148:163], v[248:251], v[32:35], v[148:163]
    buffer_load_dwordx4 v[32:35], v3, s[36:39], s51 offen offset:3072
    s_add_u32 s51, s51, 4096
    s_waitcnt vmcnt(13) lgkmcnt(0)
    v_mfma_f32_32x32x16_bf16 v[100:115], v[236:239], v[36:39], v[100:115]
    v_mfma_f32_32x32x16_bf16 v[116:131], v[240:243], v[36:39], v[116:131]
    buffer_load_dwordx4 v[36:39], v3, s[36:39], s51 offen offset:0
    s_waitcnt vmcnt(13)
    v_mfma_f32_32x32x16_bf16 v[132:147], v[236:239], v[40:43], v[132:147]
    v_mfma_f32_32x32x16_bf16 v[148:163], v[240:243], v[40:43], v[148:163]
    buffer_load_dwordx4 v[40:43], v3, s[36:39], s51 offen offset:1024
    s_waitcnt vmcnt(13)
    v_mfma_f32_32x32x16_bf16 v[100:115], v[164:167], v[44:47], v[100:115]
    v_mfma_f32_32x32x16_bf16 v[116:131], v[168:171], v[44:47], v[116:131]
    buffer_load_dwordx4 v[44:47], v3, s[36:39], s51 offen offset:2048
    s_waitcnt vmcnt(13)
    v_mfma_f32_32x32x16_bf16 v[132:147], v[164:167], v[48:51], v[132:147]
    v_mfma_f32_32x32x16_bf16 v[148:163], v[168:171], v[48:51], v[148:163]
    buffer_load_dwordx4 v[48:51], v3, s[36:39], s51 offen offset:3072
    s_add_u32 s51, s51, 4096
    s_waitcnt vmcnt(13)
    v_mfma_f32_32x32x16_bf16 v[100:115], v[172:175], v[52:55], v[100:115]
    v_mfma_f32_32x32x16_bf16 v[116:131], v[176:179], v[52:55], v[116:131]
    buffer_load_dwordx4 v[52:55], v3, s[36:39], s51 offen offset:0
    s_waitcnt vmcnt(13)
    v_mfma_f32_32x32x16_bf16 v[100:115], v[180:183], v[56:59], v[100:115]
    v_mfma_f32_32x32x16_bf16 v[116:131], v[184:187], v[56:59], v[116:131]
    buffer_load_dwordx4 v[56:59], v3, s[36:39], s51 offen offset:1024
    s_cmp_lt_u32 s3, 4
    s_cbranch_scc1 D_BX
    s_barrier
D_BX:
    s_waitcnt vmcnt(13)
    v_mfma_f32_32x32x16_bf16 v[100:115], v[188:191], v[4:7], v[100:115]
    v_mfma_f32_32x32x16_bf16 v[116:131], v[192:195], v[4:7], v[116:131]
    s_waitcnt vmcnt(12)
    v_mfma_f32_32x32x16_bf16 v[100:115], v[196:199], v[8:11], v[100:115]
    v_mfma_f32_32x32x16_bf16 v[116:131], v[200:203], v[8:11], v[116:131]
    v_and_b32 v4, 31, v1
    v_mul_u32_u24 v4, 272, v4
    v_lshrrev_b32 v5, 5, v1
    v_lshl_add_u32 v4, v5, 5, v4
    s_mul_i32 s47, s3, 17408
    v_add_u32 v4, s47, v4
    s_waitcnt vmcnt(11)
    v_mfma_f32_32x32x16_bf16 v[100:115], v[204:207], v[12:15], v[100:115]
    v_mfma_f32_32x32x16_bf16 v[116:131], v[208:211], v[12:15], v[116:131]
    s_waitcnt vmcnt(10)
    v_mfma_f32_32x32x16_bf16 v[100:115], v[212:215], v[16:19], v[100:115]
    v_mfma_f32_32x32x16_bf16 v[116:131], v[216:219], v[16:19], v[116:131]
    s_waitcnt vmcnt(9)
    v_mfma_f32_32x32x16_bf16 v[100:115], v[220:223], v[20:23], v[100:115]
    v_mfma_f32_32x32x16_bf16 v[116:131], v[224:227], v[20:23], v[116:131]
    s_waitcnt vmcnt(8)
    v_mfma_f32_32x32x16_bf16 v[100:115], v[228:231], v[24:27], v[100:115]
    v_mfma_f32_32x32x16_bf16 v[116:131], v[232:235], v[24:27], v[116:131]
    s_waitcnt vmcnt(7)
    v_mfma_f32_32x32x16_bf16 v[132:147], v[172:175], v[28:31], v[132:147]
    v_mfma_f32_32x32x16_bf16 v[148:163], v[176:179], v[28:31], v[148:163]
    s_waitcnt vmcnt(6)
    v_mfma_f32_32x32x16_bf16 v[132:147], v[180:183], v[32:35], v[132:147]
    v_mfma_f32_32x32x16_bf16 v[148:163], v[184:187], v[32:35], v[148:163]
    s_nop 7
    s_nop 7
    ds_write_b128 v4, v[100:103] offset:0
    ds_write_b128 v4, v[116:119] offset:16
    ds_write_b128 v4, v[104:107] offset:64
    ds_write_b128 v4, v[120:123] offset:80
    ds_write_b128 v4, v[108:111] offset:128
    ds_write_b128 v4, v[124:127] offset:144
    ds_write_b128 v4, v[112:115] offset:192
    ds_write_b128 v4, v[128:131] offset:208
    s_waitcnt vmcnt(5)
    v_mfma_f32_32x32x16_bf16 v[132:147], v[188:191], v[36:39], v[132:147]
    v_mfma_f32_32x32x16_bf16 v[148:163], v[192:195], v[36:39], v[148:163]
    s_waitcnt vmcnt(4)
    v_mfma_f32_32x32x16_bf16 v[132:147], v[196:199], v[40:43], v[132:147]
    v_mfma_f32_32x32x16_bf16 v[148:163], v[200:203], v[40:43], v[148:163]
    s_waitcnt vmcnt(3)
    v_mfma_f32_32x32x16_bf16 v[132:147], v[204:207], v[44:47], v[132:147]
    v_mfma_f32_32x32x16_bf16 v[148:163], v[208:211], v[44:47], v[148:163]
    s_waitcnt vmcnt(2)
    v_mfma_f32_32x32x16_bf16 v[132:147], v[212:215], v[48:51], v[132:147]
    v_mfma_f32_32x32x16_bf16 v[148:163], v[216:219], v[48:51], v[148:163]
    s_waitcnt vmcnt(1)
    v_mfma_f32_32x32x16_bf16 v[132:147], v[220:223], v[52:55], v[132:147]
    v_mfma_f32_32x32x16_bf16 v[148:163], v[224:227], v[52:55], v[148:163]
    s_waitcnt vmcnt(0)
    v_mfma_f32_32x32x16_bf16 v[132:147], v[228:231], v[56:59], v[132:147]
    v_mfma_f32_32x32x16_bf16 v[148:163], v[232:235], v[56:59], v[148:163]
    v_and_b32 v5, 31, v60
    v_mul_u32_u24 v5, 272, v5
    v_lshl_add_u32 v5, v61, 5, v5
    v_lshrrev_b32 v6, 5, v60
    v_mul_u32_u24 v6, 8704, v6
    v_add_u32 v5, v5, v6
    v_add_u32 v6, 69632, v5
    s_nop 7
    s_nop 3
    ds_write_b128 v4, v[132:135] offset:8704
    ds_write_b128 v4, v[148:151] offset:8720
    ds_write_b128 v4, v[136:139] offset:8768
    ds_write_b128 v4, v[152:155] offset:8784
    ds_write_b128 v4, v[140:143] offset:8832
    ds_write_b128 v4, v[156:159] offset:8848
    ds_write_b128 v4, v[144:147] offset:8896
    ds_write_b128 v4, v[160:163] offset:8912
    s_cmp_ge_u32 s3, 4
    s_cbranch_scc1 D_SC
    s_waitcnt lgkmcnt(0)
    s_barrier
    ds_read_b128 v[100:103], v5 offset:0
    ds_read_b128 v[104:107], v5 offset:16
    ds_read_b128 v[108:111], v5 offset:17408
    ds_read_b128 v[112:115], v5 offset:17424
    ds_read_b128 v[116:119], v5 offset:34816
    ds_read_b128 v[120:123], v5 offset:34832
    ds_read_b128 v[124:127], v5 offset:52224
    ds_read_b128 v[128:131], v5 offset:52240
    ds_read_b128 v[132:135], v5 offset:8704
    ds_read_b128 v[136:139], v5 offset:8720
    ds_read_b128 v[140:143], v5 offset:26112
    ds_read_b128 v[144:147], v5 offset:26128
    ds_read_b128 v[148:151], v5 offset:43520
    ds_read_b128 v[152:155], v5 offset:43536
    ds_read_b128 v[156:159], v5 offset:60928
    ds_read_b128 v[160:163], v5 offset:60944
    s_waitcnt lgkmcnt(12)
    v_add_f32 v100, v100, v108
    v_add_f32 v101, v101, v109
    v_add_f32 v102, v102, v110
    v_add_f32 v103, v103, v111
    v_add_f32 v104, v104, v112
    v_add_f32 v105, v105, v113
    v_add_f32 v106, v106, v114
    v_add_f32 v107, v107, v115
    s_waitcnt lgkmcnt(10)
    v_add_f32 v100, v100, v116
    v_add_f32 v101, v101, v117
    v_add_f32 v102, v102, v118
    v_add_f32 v103, v103, v119
    v_add_f32 v104, v104, v120
    v_add_f32 v105, v105, v121
    v_add_f32 v106, v106, v122
    v_add_f32 v107, v107, v123
    s_waitcnt lgkmcnt(8)
    v_add_f32 v100, v100, v124
    v_add_f32 v101, v101, v125
    v_add_f32 v102, v102, v126
    v_add_f32 v103, v103, v127
    v_add_f32 v104, v104, v128
    v_add_f32 v105, v105, v129
    v_add_f32 v106, v106, v130
    v_add_f32 v107, v107, v131
    ds_write_b128 v5, v[100:103]
    ds_write_b128 v5, v[104:107] offset:16
    s_waitcnt lgkmcnt(6)
    v_add_f32 v132, v132, v140
    v_add_f32 v133, v133, v141
    v_add_f32 v134, v134, v142
    v_add_f32 v135, v135, v143
    v_add_f32 v136, v136, v144
    v_add_f32 v137, v137, v145
    v_add_f32 v138, v138, v146
    v_add_f32 v139, v139, v147
    s_waitcnt lgkmcnt(4)
    v_add_f32 v132, v132, v148
    v_add_f32 v133, v133, v149
    v_add_f32 v134, v134, v150
    v_add_f32 v135, v135, v151
    v_add_f32 v136, v136, v152
    v_add_f32 v137, v137, v153
    v_add_f32 v138, v138, v154
    v_add_f32 v139, v139, v155
    s_waitcnt lgkmcnt(2)
    v_add_f32 v132, v132, v156
    v_add_f32 v133, v133, v157
    v_add_f32 v134, v134, v158
    v_add_f32 v135, v135, v159
    v_add_f32 v136, v136, v160
    v_add_f32 v137, v137, v161
    v_add_f32 v138, v138, v162
    v_add_f32 v139, v139, v163
    ds_write_b128 v5, v[132:135] offset:8704
    ds_write_b128 v5, v[136:139] offset:8720
D_SC:
    v_lshlrev_b32 v48, 16, v64
    v_and_b32 v49, 0xffff0000, v64
    v_lshlrev_b32 v52, 16, v66
    v_and_b32 v53, 0xffff0000, v66
    v_lshlrev_b32 v50, 16, v65
    v_and_b32 v51, 0xffff0000, v65
    v_lshlrev_b32 v54, 16, v67
    v_and_b32 v55, 0xffff0000, v67
    s_waitcnt lgkmcnt(0)
    s_barrier
    ds_read_b128 v[100:103], v5 offset:0
    ds_read_b128 v[104:107], v5 offset:16
    ds_read_b128 v[108:111], v6 offset:0
    ds_read_b128 v[112:115], v6 offset:16
    ds_read_b128 v[116:119], v6 offset:17408
    ds_read_b128 v[120:123], v6 offset:17424
    ds_read_b128 v[124:127], v6 offset:34816
    ds_read_b128 v[128:131], v6 offset:34832
    ds_read_b128 v[132:135], v6 offset:52224
    ds_read_b128 v[136:139], v6 offset:52240
    s_waitcnt lgkmcnt(8)
    v_add_f32 v48, v48, v100
    v_add_f32 v49, v49, v101
    v_add_f32 v50, v50, v102
    v_add_f32 v51, v51, v103
    v_add_f32 v52, v52, v104
    v_add_f32 v53, v53, v105
    v_add_f32 v54, v54, v106
    v_add_f32 v55, v55, v107
    s_waitcnt lgkmcnt(6)
    v_add_f32 v48, v48, v108
    v_add_f32 v49, v49, v109
    v_add_f32 v50, v50, v110
    v_add_f32 v51, v51, v111
    v_add_f32 v52, v52, v112
    v_add_f32 v53, v53, v113
    v_add_f32 v54, v54, v114
    v_add_f32 v55, v55, v115
    s_waitcnt lgkmcnt(4)
    v_add_f32 v48, v48, v116
    v_add_f32 v49, v49, v117
    v_add_f32 v50, v50, v118
    v_add_f32 v51, v51, v119
    v_add_f32 v52, v52, v120
    v_add_f32 v53, v53, v121
    v_add_f32 v54, v54, v122
    v_add_f32 v55, v55, v123
    s_waitcnt lgkmcnt(2)
    v_add_f32 v48, v48, v124
    v_add_f32 v49, v49, v125
    v_add_f32 v50, v50, v126
    v_add_f32 v51, v51, v127
    v_add_f32 v52, v52, v128
    v_add_f32 v53, v53, v129
    v_add_f32 v54, v54, v130
    v_add_f32 v55, v55, v131
    s_waitcnt lgkmcnt(0)
    v_add_f32 v48, v48, v132
    v_add_f32 v49, v49, v133
    v_add_f32 v50, v50, v134
    v_add_f32 v51, v51, v135
    v_add_f32 v52, v52, v136
    v_add_f32 v53, v53, v137
    v_add_f32 v54, v54, v138
    v_add_f32 v55, v55, v139
    v_cvt_pk_bf16_f32 v56, v48, v52
    v_cvt_pk_bf16_f32 v57, v49, v53
    v_cvt_pk_bf16_f32 v58, v50, v54
    v_cvt_pk_bf16_f32 v59, v51, v55
    buffer_store_dwordx4 v[56:59], v62, s[20:23], s53 offen
K_END:
    s_endpgm
.section .rodata,"a"
.p2align 6
.amdhsa_kernel sequential_preLN__grouped_kv_mqa__dense_activation_mish__prompt_kernel
  .amdhsa_next_free_vgpr 256
  .amdhsa_next_free_sgpr 102
  .amdhsa_accum_offset 256
  .amdhsa_group_segment_fixed_size 0
  .amdhsa_kernarg_size 96
  .amdhsa_user_sgpr_count 2
  .amdhsa_user_sgpr_kernarg_segment_ptr 1
  .amdhsa_system_sgpr_workgroup_id_x 1
.end_amdhsa_kernel
```
